```python
import torch

def _softmax(x, axis=-1):
    return torch.softmax(x, dim=axis)
def _gelu(x):
    return torch.nn.functional.gelu(x, approximate="tanh")
def _silu(x):
    return torch.nn.functional.silu(x)
def _sigmoid(x):
    return torch.sigmoid(x)
def _layernorm(x, axis=-1, eps=1e-5):
    m = x.mean(dim=axis, keepdim=True)
    v = x.var(dim=axis, keepdim=True, unbiased=False)
    return (x - m) / torch.sqrt(v + eps)
def _scatter_add(tgt, idx, src, axis=0):
    return tgt.clone().index_add_(axis, idx, src)
def _segment_sum(src, seg, n):
    out = torch.zeros((n,) + src.shape[1:], dtype=src.dtype)
    return out.index_add_(0, seg, src)
def _pad(x, pw):
    flat = tuple(v for pair in reversed(pw) for v in pair)
    return torch.nn.functional.pad(x, flat)

kernel_name = 'gated_mix__linear_kernel_hedgehog__dense_activation_relu__prompt'

def setup_inputs():

    _w = (lambda a: (lambda t: t.to(torch.bfloat16) if t.is_floating_point() else t)(torch.as_tensor(a)))
    def _A_setup():
        B, S, D, H = 1, 2048, 512, 32
        Dh = D // H
        return {
            "x": _w((lambda *s: torch.randn(*s, dtype=torch.bfloat16) * 0.05)(B, S, D)),
            "wqkv": _w((lambda *s: torch.randn(*s, dtype=torch.bfloat16) * 1.6)(D, 3 * D)),
            "w_phi": _w((lambda *s: torch.randn(*s, dtype=torch.bfloat16) * 1.6)(H, Dh, Dh) * (Dh ** -0.5)),
            "wo": _w((lambda *s: torch.randn(*s, dtype=torch.bfloat16) * 0.1)(D, D)),
        }
    _A_in = _A_setup()

    def _B_setup():
        B, S, D, Dff = 1, 2048, 512, 1376
        return {
            "x": _w((lambda *s: torch.randn(*s, dtype=torch.bfloat16) * 0.05)(B, S, D)),
            "w1": _w((lambda *s: torch.randn(*s, dtype=torch.bfloat16) * 0.05)(D, Dff)),
            "w2": _w((lambda *s: torch.randn(*s, dtype=torch.bfloat16) * 0.05)(Dff, D)),
        }
    _B_in = _B_setup()

    return {
        "A_x": _A_in["x"],
        "A_wqkv": _A_in["wqkv"],
        "A_w_phi": _A_in["w_phi"],
        "A_wo": _A_in["wo"],
        "B_x": _B_in["x"],
        "B_w1": _B_in["w1"],
        "B_w2": _B_in["w2"],
        "gate_w": _w((lambda *s: torch.randn(*s, dtype=torch.bfloat16) * 0.05)(512) * 16.0),
    }

def reference(A_x, A_wqkv, A_w_phi, A_wo, B_x, B_w1, B_w2, gate_w):
    def _A_ref(x, wqkv, w_phi, wo):
        B, S, D = x.shape
        H = 32; Dh = D // H
        qkv = (lambda x, *d: x.permute(*d))((x @ wqkv).reshape(B, S, 3, H, Dh), 2, 0, 3, 1, 4)
        q, k, v = qkv[0], qkv[1], qkv[2]
        pq = torch.einsum("bhsd,hdf->bhsf", q, w_phi)
        pk = torch.einsum("bhsd,hdf->bhsf", k, w_phi)
        phi_q = torch.concatenate([_softmax(pq, axis=-1), _softmax(-pq, axis=-1)], axis=-1)
        phi_k = torch.concatenate([_softmax(pk, axis=-1), _softmax(-pk, axis=-1)], axis=-1)
        kv = torch.einsum("bhsf,bhsd->bhfd", phi_k, v)
        z  = torch.einsum("bhsf->bhf", phi_k)
        num = torch.einsum("bhqf,bhfd->bhqd", phi_q, kv)
        den = torch.einsum("bhqf,bhf->bhq", phi_q, z)[..., None] + 1e-6
        o = num / den
        return (lambda x, *d: x.permute(*d))(o, 0, 2, 1, 3).reshape(B, S, D) @ wo

    def _B_ref(x, w1, w2):
        h = torch.einsum("bsd,df->bsf", x, w1)
        zero = torch.zeros_like(h)
        h = torch.maximum(h, zero)
        return torch.einsum("bsf,fd->bsd", h, w2)

    x = A_x
    g = _sigmoid((x * gate_w).sum(-1, keepdims=True))
    a = _A_ref(x, A_wqkv, A_w_phi, A_wo)
    b = _B_ref(x, B_w1, B_w2)
    return g * a + (1 - g) * b
```

```asm
; @launch grid=(256,1,1) block=(256,1,1) lds=163840
.amdgcn_target "amdgcn-amd-amdhsa--gfx950"
.text
.globl gated_mix__linear_kernel_hedgehog__dense_activation_relu__prompt_kernel
.p2align 8
.type gated_mix__linear_kernel_hedgehog__dense_activation_relu__prompt_kernel,@function
gated_mix__linear_kernel_hedgehog__dense_activation_relu__prompt_kernel:
    s_cmp_ge_u32 s2, 256
    s_cbranch_scc1 L_end
    s_load_dwordx16 s[4:19], s[0:1], 0
    s_load_dwordx4 s[20:23], s[0:1], 64
    s_load_dwordx2 s[24:25], s[0:1], 80
    v_lshrrev_b32 v2, 6, v0
    v_and_b32 v1, 63, v0
    v_readfirstlane_b32 s56, v2
    s_lshr_b32 s68, s2, 3
    s_getpc_b64 s[88:89]
L_pc:
    v_lshl_add_u32 v253, s68, 2, v2
    v_lshlrev_b32 v253, 8, v253
    v_lshl_add_u32 v253, v1, 7, v253
    v_min_u32 v253, L_end-L_pc, v253
    s_mov_b64 exec, 3
    global_load_dword v0, v253, s[88:89]
    s_mov_b64 exec, -1
    s_and_b32 s63, s68, 7
    s_lshr_b32 s70, s2, 6
    s_and_b32 s69, s2, 1
    s_lshl_b32 s69, s69, 3
    s_add_u32 s57, s69, s63
    s_and_b32 s69, s2, 6
    s_and_b32 s71, s70, 1
    s_add_u32 s58, s69, s71
    s_and_b32 s59, s63, 1
    s_lshl_b32 s59, s59, 2
    s_lshl_b32 s71, s70, 2
    s_add_u32 s59, s59, s71
    s_and_b32 s59, s59, 7
    v_lshrrev_b32 v56, 3, v1
    v_and_b32 v57, 7, v1
    v_lshrrev_b32 v58, 4, v1
    v_xor_b32 v57, v57, v58
    s_lshl_b32 s68, s57, 7
    s_lshl_b32 s69, s56, 5
    s_add_u32 s68, s68, s69
    v_add_u32 v59, s68, v56
    v_lshlrev_b32 v59, 10, v59
    v_lshl_add_u32 v2, v57, 4, v59
    v_xor_b32 v3, 64, v2
    v_add_u32 v3, 7168, v3
    v_add_u32 v4, 14336, v2
    v_add_u32 v5, 14336, v3
    s_lshl_b32 s73, s56, 12
    s_lshl_b32 s66, s59, 7
    s_mov_b32 m0, s73
    s_mov_b32 s30, 2097152
    s_mov_b32 s31, 0x20000
    v_bfe_u32 v60, v1, 2, 2
    v_and_b32 v61, 3, v1
    v_xor_b32 v62, v60, v58
    v_add_u32 v60, v60, v58
    v_and_b32 v60, 3, v60
    v_lshlrev_b32 v60, 6, v60
    v_and_b32 v63, 1, v62
    v_lshrrev_b32 v62, 1, v62
    v_lshlrev_b32 v62, 10, v62
    v_lshl_add_u32 v62, v63, 6, v62
    s_lshl_b32 s68, s58, 7
    s_mov_b32 s34, 1572864
    s_mov_b32 s71, 3072
    s_cmp_ge_u32 s2, 128
    s_cselect_b64 s[96:97], -1, 0
    s_cselect_b32 s34, 1409024, s34
    s_cselect_b32 s71, 2752, s71
    s_cselect_b32 s69, s68, 1024
    s_mov_b32 s35, 0x20000
    v_cndmask_b32 v62, v62, v60, s[96:97]
    v_lshl_add_u32 v62, v61, 4, v62
    s_add_u32 s68, s68, s69
    s_lshl_b32 s69, s71, 4
    s_mul_i32 s69, s69, s56
    s_add_u32 s68, s68, s69
    v_mul_u32_u24 v63, s71, v58
    v_add3_u32 v6, v62, v63, s68
    s_lshl_b32 s69, s71, 2
    s_sub_u32 s69, s69, 1024
    v_add_u32 v7, s69, v6
    v_add_u32 v8, s69, v7
    v_add_u32 v9, s69, v8
    s_lshl_b32 s85, s71, 6
    s_mul_i32 s67, s59, s85
    s_add_u32 s74, s73, 16384
    s_lshr_b32 s60, s56, 1
    s_cmp_ge_u32 s2, 128
    s_waitcnt lgkmcnt(0)
    s_mov_b32 s28, s4
    s_mov_b32 s29, s5
    buffer_load_dwordx4 v2, s[28:31], s66 offen offset:0 lds
    buffer_load_dwordx4 v3, s[28:31], s66 offen offset:1024 lds
    buffer_load_dwordx4 v4, s[28:31], s66 offen offset:2048 lds
    buffer_load_dwordx4 v5, s[28:31], s66 offen offset:3072 lds
    s_mov_b32 m0, s74
    s_cselect_b32 s32, s14, s6
    s_cselect_b32 s33, s15, s7
    buffer_load_dwordx4 v6, s[32:35], s67 offen offset:0 lds
    buffer_load_dwordx4 v7, s[32:35], s67 offen offset:1024 lds
    buffer_load_dwordx4 v8, s[32:35], s67 offen offset:2048 lds
    buffer_load_dwordx4 v9, s[32:35], s67 offen offset:3072 lds
    s_and_b32 s61, s56, 1
    s_mov_b32 s92, s8
    s_mov_b32 s93, s9
    s_mov_b32 s94, 16384
    s_mov_b32 s95, 0x20000
    s_lshl_b32 s68, s58, 11
    s_lshl_b32 s69, s61, 10
    s_add_u32 s68, s68, s69
    s_lshl_b32 s69, s56, 10
    s_add_u32 m0, s69, 98304
    v_lshlrev_b32 v56, 4, v1
    buffer_load_dwordx4 v56, s[92:95], s68 offen lds
    s_add_u32 m0, s73, 32768
    s_add_u32 s66, s59, 1
    s_and_b32 s66, s66, 7
    s_lshl_b32 s66, s66, 7
    buffer_load_dwordx4 v2, s[28:31], s66 offen offset:0 lds
    buffer_load_dwordx4 v3, s[28:31], s66 offen offset:1024 lds
    buffer_load_dwordx4 v4, s[28:31], s66 offen offset:2048 lds
    s_and_b32 s69, s2, 7
    s_lshl_b32 s69, s69, 2
    s_add_u32 s62, s69, s70
    s_mul_i32 s71, s70, 8
    s_and_b32 s65, s63, 7
    s_mul_i32 s65, s65, 2
    s_add_u32 s65, s65, s71
    s_and_b32 s65, s65, 15
    s_mov_b32 s48, s24
    s_mov_b32 s49, s25
    s_mov_b32 s50, 268435456
    s_mov_b32 s51, 0x20000
    s_mov_b32 s40, s16
    s_mov_b32 s41, s17
    s_mov_b32 s42, 1409024
    s_mov_b32 s43, 0x20000
    s_mov_b32 s44, s10
    s_mov_b32 s45, s11
    s_mov_b32 s46, 524288
    s_mov_b32 s47, 0x20000
    s_mov_b32 s52, s20
    s_mov_b32 s53, s21
    s_mov_b32 s54, 2097152
    s_mov_b32 s55, 0x20000
    v_lshrrev_b32 v56, 5, v1
    v_bfe_u32 v57, v1, 4, 1
    v_bfe_u32 v58, v1, 2, 2
    v_and_b32 v59, 3, v1
    v_and_b32 v60, 31, v1
    v_bfe_u32 v61, v1, 1, 3
    v_xor_b32 v61, v61, v56
    s_lshl_b32 s68, s60, 13
    v_lshl_add_u32 v60, v60, 7, s68
    v_lshl_add_u32 v14, v61, 4, v60
    v_xor_b32 v15, 32, v14
    v_xor_b32 v16, 64, v14
    v_xor_b32 v17, 96, v14
    v_add_u32 v18, 65536, v14
    v_add_u32 v19, 65536, v15
    v_add_u32 v20, 65536, v16
    v_add_u32 v21, 65536, v17
    v_lshlrev_b32 v60, 3, v59
    v_lshl_add_u32 v60, v57, 5, v60
    v_lshl_add_u32 v61, v56, 3, v58
    v_lshl_add_u32 v62, v61, 8, v60
    v_xor_b32 v63, s61, v58
    v_sub_u32 v23, s61, v58
    v_and_b32 v23, 3, v23
    v_cndmask_b32 v63, v63, v23, s[96:97]
    v_lshl_add_u32 v62, v63, 6, v62
    v_add_u32 v22, 16384, v62
    v_xor_b32 v23, 128, v22
    v_add_u32 v24, 65536, v22
    v_add_u32 v25, 65536, v23
    v_lshrrev_b32 v63, 1, v58
    v_xor_b32 v62, s61, v63
    v_lshl_add_u32 v62, v62, 6, v60
    v_lshl_add_u32 v62, v61, 7, v62
    v_add_u32 v26, 98304, v62
    v_lshl_add_u32 v61, v56, 2, v58
    v_xor_b32 v63, s60, v63
    v_lshl_add_u32 v62, v63, 6, v60
    v_lshl_add_u32 v62, v61, 7, v62
    s_mul_i32 s76, s56, 22528
    s_lshl_b32 s77, s56, 14
    s_add_u32 s77, s77, 98304
    v_add_u32 v27, s76, v62
    v_xor_b32 v28, 64, v27
    v_add_u32 v29, s77, v62
    v_xor_b32 v30, 64, v29
    s_lshl_b32 s75, s56, 11
    s_add_u32 s75, s75, 98304
    v_lshrrev_b32 v62, 1, v59
    v_lshl_add_u32 v62, v57, 1, v62
    v_lshlrev_b32 v62, 3, v62
    v_lshl_add_u32 v62, v61, 5, v62
    s_lshl_b32 s68, s56, 10
    s_add_u32 s68, s68, 98304
    v_add_u32 v36, s68, v62
    v_lshlrev_b32 v60, 4, v1
    s_lshl_b32 s68, s62, 1
    s_add_u32 s69, s68, s61
    s_xor_b32 s70, s69, 1
    s_mul_i32 s69, s69, 120832
    s_mul_i32 s70, s70, 120832
    s_lshl_b32 s71, s56, 14
    s_add_u32 s69, s69, s71
    s_add_u32 s70, s70, s71
    v_add_u32 v31, s69, v60
    v_add_u32 v32, s70, v60
    s_lshl_b32 s68, s57, 1
    s_add_u32 s68, s68, s60
    s_lshl_b32 s100, s68, 8
    s_mul_i32 s68, s68, 241664
    v_add_u32 v33, s68, v60
    v_add_u32 v34, 120832, v33
    s_lshl_b32 s69, s58, 1
    s_add_u32 s69, s69, s61
    s_mul_i32 s26, s69, 6144
    s_add_u32 s26, s26, 8388608
    s_lshl_b32 s69, s69, 2
    s_add_u32 s100, s100, s69
    s_lshl_b32 s101, s62, 8
    s_add_u32 s101, s101, 10485760
    s_mov_b32 s98, 0x3fb8aa3b
    s_mov_b32 s86, 0xffff0000
    s_mov_b32 s87, 0xffff0000
    s_mul_i32 s78, s56, 6
    s_cmp_eq_u32 s56, 3
    s_cselect_b32 s78, 17, s78
    s_add_u32 s78, s78, 64
    s_cmp_ge_u32 s56, 2
    s_cselect_b32 s80, 5, 6
    s_lshl_b32 s79, s80, 14
    s_lshl_b32 s80, s80, 10
    s_lshl_b32 s81, s65, 14
    s_lshl_b32 s82, s65, 10
    v_bfe_u32 v60, v1, 2, 1
    v_mul_u32_u24 v62, 0x8000, v60
    v_lshl_or_b32 v38, v62, 16, v62
    v_xor_b32 v61, v60, v57
    v_lshrrev_b32 v60, 3, v1
    v_lshlrev_b32 v62, 4, v59
    v_lshl_add_u32 v63, v61, 6, v62
    s_lshl_b32 s68, s63, 7
    s_lshl_b32 s69, s56, 18
    s_add_u32 s68, s68, s69
    v_lshl_add_u32 v12, v60, 10, v63
    v_add_u32 v12, s68, v12
    v_add_u32 v13, 7168, v12
    s_cmp_ge_u32 s2, 128
    s_cbranch_scc1 L_Q
L_KV:
    s_mov_b32 s36, s14
    s_mov_b32 s37, s15
    s_mov_b32 s38, 1409024
    s_mov_b32 s39, 0x20000
    s_mul_i32 s83, s58, 3
    s_add_u32 s83, s83, 1
    s_lshr_b32 s83, s83, 1
    s_min_u32 s83, s83, 10
    s_add_u32 s83, s83, 32
    s_mov_b32 s84, 64
    s_bitcmp1_b32 s58, 0
    s_cselect_b32 s84, 0, s84
    s_cmp_eq_u32 s58, 6
    s_cselect_b32 s84, 0, s84
    s_cmp_eq_u32 s84, 0
    s_cselect_b32 s69, 0x40000000, s84
    v_mul_lo_u32 v63, s69, v61
    v_add_u32 v63, v63, v62
    s_lshl_b32 s68, s83, 6
    s_mul_i32 s69, s56, 44032
    s_add_u32 s68, s68, s69
    v_mul_u32_u24 v60, 2752, v60
    v_add3_u32 v10, v60, v63, s68
    v_add_u32 v11, 20992, v10
    v_and_b32 v61, 1, v1
    v_mul_u32_u24 v61, 0x3f80, v61
    v_lshlrev_b32 v61, 16, v61
    v_and_b32 v60, 1, v1
    v_xor_b32 v60, 1, v60
    v_mul_u32_u24 v60, 0x3f80, v60
    v_or_b32 v60, v60, v61
    v_bfe_u32 v61, v1, 1, 4
    v_xor_b32 v62, s60, v56
    v_lshlrev_b32 v62, 3, v62
    v_sub_u32 v61, v61, v62
    v_cmp_eq_u32 vcc, 0, v61
    s_nop 1
    v_cndmask_b32 v208, 0, v60, vcc
    v_cmp_eq_u32 vcc, 1, v61
    s_nop 1
    v_cndmask_b32 v209, 0, v60, vcc
    v_cmp_eq_u32 vcc, 2, v61
    s_nop 1
    v_cndmask_b32 v210, 0, v60, vcc
    v_cmp_eq_u32 vcc, 3, v61
    s_nop 1
    v_cndmask_b32 v211, 0, v60, vcc
    v_cmp_eq_u32 vcc, 4, v61
    s_nop 1
    v_cndmask_b32 v212, 0, v60, vcc
    v_cmp_eq_u32 vcc, 5, v61
    s_nop 1
    v_cndmask_b32 v213, 0, v60, vcc
    v_cmp_eq_u32 vcc, 6, v61
    s_nop 1
    v_cndmask_b32 v214, 0, v60, vcc
    v_cmp_eq_u32 vcc, 7, v61
    s_nop 1
    v_cndmask_b32 v215, 0, v60, vcc
    s_xor_b32 s68, s2, 9
    s_or_b32 s68, s68, s56
    s_cmp_lg_u32 s68, 0
    s_cbranch_scc1 LKV_nononce1
    s_memrealtime s[92:93]
    s_waitcnt lgkmcnt(0)
    s_or_b32 s92, s92, 1
    v_mov_b32 v56, 0
    v_mov_b32 v57, s92
    s_mov_b64 exec, 1
    global_store_dword v56, v57, s[22:23] sc1
    s_mov_b64 exec, -1
LKV_nononce1:
    s_cmp_lg_u32 s57, 10
    s_cbranch_scc1 LKV_nozero2
    s_mul_i32 s68, s58, 12288
    s_mul_i32 s69, s56, 3072
    s_add_u32 s68, s68, s69
    s_add_u32 s68, s68, 8388608
    v_lshlrev_b32 v56, 4, v1
    v_mov_b32 v60, 0
    v_mov_b32 v61, 0
    v_mov_b32 v62, 0
    v_mov_b32 v63, 0
    buffer_store_dwordx4 v[60:63], v56, s[48:51], s68 offen sc1
    buffer_store_dwordx4 v[60:63], v56, s[48:51], s68 offen offset:1024 sc1
    buffer_store_dwordx4 v[60:63], v56, s[48:51], s68 offen offset:2048 sc1
LKV_nozero2:
    buffer_load_dwordx4 v5, s[28:31], s66 offen offset:3072 lds
    s_lshr_b32 s67, s66, 7
    s_add_u32 m0, s74, 32768
    s_mul_i32 s67, s67, s85
    buffer_load_dwordx4 v6, s[32:35], s67 offen offset:0 lds
    buffer_load_dwordx4 v7, s[32:35], s67 offen offset:1024 lds
    buffer_load_dwordx4 v8, s[32:35], s67 offen offset:2048 lds
    buffer_load_dwordx4 v9, s[32:35], s67 offen offset:3072 lds
    s_waitcnt vmcnt(8)
    s_barrier
    ds_read_b64_tr_b16 v[216:217], v36 offset:0
    ds_read_b64_tr_b16 v[218:219], v36 offset:256
    ds_read_b64_tr_b16 v[220:221], v36 offset:512
    ds_read_b64_tr_b16 v[222:223], v36 offset:768
    ds_read_b64_tr_b16 v[40:41], v22 offset:0
    ds_read_b64_tr_b16 v[42:43], v22 offset:1024
    ds_read_b128 a[0:3], v14 offset:0
    ds_read_b64_tr_b16 v[44:45], v23 offset:0
    ds_read_b64_tr_b16 v[46:47], v23 offset:1024
    ds_read_b128 a[128:131], v14 offset:4096
    s_waitcnt lgkmcnt(6)
    v_xor_b32 v216, v38, v216
    v_xor_b32 v217, v38, v217
    v_xor_b32 v218, v38, v218
    v_xor_b32 v219, v38, v219
    v_xor_b32 v220, v38, v220
    v_xor_b32 v221, v38, v221
    v_xor_b32 v222, v38, v222
    v_xor_b32 v223, v38, v223
    s_waitcnt lgkmcnt(0)
    v_mfma_f32_32x32x16_bf16 v[64:79], v[40:43], a[0:3], 0
    ds_read_b64_tr_b16 v[48:49], v22 offset:4096
    ds_read_b64_tr_b16 v[50:51], v22 offset:5120
    ds_read_b128 a[4:7], v15 offset:0
    ds_read_b64_tr_b16 v[52:53], v23 offset:4096
    s_add_u32 m0, s73, 65536
    s_add_u32 s66, s59, 2
    s_and_b32 s66, s66, 7
    s_lshl_b32 s66, s66, 7
    buffer_load_dwordx4 v2, s[28:31], s66 offen offset:0 lds
    v_mfma_f32_32x32x16_bf16 v[80:95], v[40:43], a[128:131], 0
    ds_read_b64_tr_b16 v[54:55], v23 offset:5120
    ds_read_b128 a[132:135], v15 offset:4096
    buffer_load_dwordx4 v3, s[28:31], s66 offen offset:1024 lds
    v_mfma_f32_32x32x16_bf16 v[96:111], a[0:3], v[44:47], 0
    v_mfma_f32_32x32x16_bf16 v[112:127], a[128:131], v[44:47], 0
    buffer_load_dwordx4 v4, s[28:31], s66 offen offset:2048 lds
    s_waitcnt lgkmcnt(0)
    v_mfma_f32_32x32x16_bf16 v[64:79], v[48:51], a[4:7], v[64:79]
    ds_read_b64_tr_b16 v[40:41], v22 offset:8192
    ds_read_b64_tr_b16 v[42:43], v22 offset:9216
    ds_read_b128 a[8:11], v16 offset:0
    ds_read_b64_tr_b16 v[44:45], v23 offset:8192
    buffer_load_dwordx4 v5, s[28:31], s66 offen offset:3072 lds
    v_mfma_f32_32x32x16_bf16 v[80:95], v[48:51], a[132:135], v[80:95]
    ds_read_b64_tr_b16 v[46:47], v23 offset:9216
    ds_read_b128 a[136:139], v16 offset:4096
    s_lshr_b32 s67, s66, 7
    s_add_u32 m0, s74, 65536
    s_mul_i32 s67, s67, s85
    buffer_load_dwordx4 v6, s[32:35], s67 offen offset:0 lds
    v_mfma_f32_32x32x16_bf16 v[96:111], a[4:7], v[52:55], v[96:111]
    v_mfma_f32_32x32x16_bf16 v[112:127], a[132:135], v[52:55], v[112:127]
    buffer_load_dwordx4 v7, s[32:35], s67 offen offset:1024 lds
    s_waitcnt lgkmcnt(0)
    v_mfma_f32_32x32x16_bf16 v[64:79], v[40:43], a[8:11], v[64:79]
    ds_read_b64_tr_b16 v[48:49], v22 offset:12288
    ds_read_b64_tr_b16 v[50:51], v22 offset:13312
    ds_read_b128 a[12:15], v17 offset:0
    ds_read_b64_tr_b16 v[52:53], v23 offset:12288
    buffer_load_dwordx4 v8, s[32:35], s67 offen offset:2048 lds
    v_mfma_f32_32x32x16_bf16 v[80:95], v[40:43], a[136:139], v[80:95]
    ds_read_b64_tr_b16 v[54:55], v23 offset:13312
    ds_read_b128 a[140:143], v17 offset:4096
    buffer_load_dwordx4 v9, s[32:35], s67 offen offset:3072 lds
    v_mfma_f32_32x32x16_bf16 v[96:111], a[8:11], v[44:47], v[96:111]
    v_mfma_f32_32x32x16_bf16 v[112:127], a[136:139], v[44:47], v[112:127]
    s_waitcnt lgkmcnt(0)
    s_waitcnt vmcnt(8)
    s_barrier
    v_mfma_f32_32x32x16_bf16 v[64:79], v[48:51], a[12:15], v[64:79]
    ds_read_b64_tr_b16 v[40:41], v22 offset:32768
    ds_read_b64_tr_b16 v[42:43], v22 offset:33792
    ds_read_b128 a[16:19], v14 offset:32768
    ds_read_b64_tr_b16 v[44:45], v23 offset:32768
    v_mfma_f32_32x32x16_bf16 v[80:95], v[48:51], a[140:143], v[80:95]
    ds_read_b64_tr_b16 v[46:47], v23 offset:33792
    ds_read_b128 a[144:147], v14 offset:36864
    v_mfma_f32_32x32x16_bf16 v[96:111], a[12:15], v[52:55], v[96:111]
    s_add_u32 m0, s73, 0
    s_add_u32 s66, s59, 3
    s_and_b32 s66, s66, 7
    s_lshl_b32 s66, s66, 7
    buffer_load_dwordx4 v2, s[28:31], s66 offen offset:0 lds
    v_mfma_f32_32x32x16_bf16 v[112:127], a[140:143], v[52:55], v[112:127]
    buffer_load_dwordx4 v3, s[28:31], s66 offen offset:1024 lds
    s_waitcnt lgkmcnt(0)
    v_mfma_f32_32x32x16_bf16 v[64:79], v[40:43], a[16:19], v[64:79]
    ds_read_b64_tr_b16 v[48:49], v22 offset:36864
    ds_read_b64_tr_b16 v[50:51], v22 offset:37888
    ds_read_b128 a[20:23], v15 offset:32768
    ds_read_b64_tr_b16 v[52:53], v23 offset:36864
    v_mfma_f32_32x32x16_bf16 v[80:95], v[40:43], a[144:147], v[80:95]
    ds_read_b64_tr_b16 v[54:55], v23 offset:37888
    ds_read_b128 a[148:151], v15 offset:36864
    v_mfma_f32_32x32x16_bf16 v[96:111], a[16:19], v[44:47], v[96:111]
    buffer_load_dwordx4 v4, s[28:31], s66 offen offset:2048 lds
    v_mfma_f32_32x32x16_bf16 v[112:127], a[144:147], v[44:47], v[112:127]
    buffer_load_dwordx4 v5, s[28:31], s66 offen offset:3072 lds
    s_waitcnt lgkmcnt(0)
    v_mfma_f32_32x32x16_bf16 v[64:79], v[48:51], a[20:23], v[64:79]
    ds_read_b64_tr_b16 v[40:41], v22 offset:40960
    ds_read_b64_tr_b16 v[42:43], v22 offset:41984
    ds_read_b128 a[24:27], v16 offset:32768
    ds_read_b64_tr_b16 v[44:45], v23 offset:40960
    v_mfma_f32_32x32x16_bf16 v[80:95], v[48:51], a[148:151], v[80:95]
    ds_read_b64_tr_b16 v[46:47], v23 offset:41984
    ds_read_b128 a[152:155], v16 offset:36864
    v_mfma_f32_32x32x16_bf16 v[96:111], a[20:23], v[52:55], v[96:111]
    s_lshr_b32 s67, s66, 7
    s_add_u32 m0, s74, 0
    s_mul_i32 s67, s67, s85
    buffer_load_dwordx4 v6, s[32:35], s67 offen offset:0 lds
    v_mfma_f32_32x32x16_bf16 v[112:127], a[148:151], v[52:55], v[112:127]
    buffer_load_dwordx4 v7, s[32:35], s67 offen offset:1024 lds
    s_waitcnt lgkmcnt(0)
    v_mfma_f32_32x32x16_bf16 v[64:79], v[40:43], a[24:27], v[64:79]
    ds_read_b64_tr_b16 v[48:49], v22 offset:45056
    ds_read_b64_tr_b16 v[50:51], v22 offset:46080
    ds_read_b128 a[28:31], v17 offset:32768
    ds_read_b64_tr_b16 v[52:53], v23 offset:45056
    v_mfma_f32_32x32x16_bf16 v[80:95], v[40:43], a[152:155], v[80:95]
    ds_read_b64_tr_b16 v[54:55], v23 offset:46080
    ds_read_b128 a[156:159], v17 offset:36864
    v_mfma_f32_32x32x16_bf16 v[96:111], a[24:27], v[44:47], v[96:111]
    buffer_load_dwordx4 v8, s[32:35], s67 offen offset:2048 lds
    v_mfma_f32_32x32x16_bf16 v[112:127], a[152:155], v[44:47], v[112:127]
    buffer_load_dwordx4 v9, s[32:35], s67 offen offset:3072 lds
    s_waitcnt lgkmcnt(0)
    s_waitcnt vmcnt(8)
    s_barrier
    s_lshl_b32 s69, s2, 2
    s_add_u32 s69, s69, s56
    s_lshr_b32 s70, s69, 1
    s_and_b32 s69, s69, 1
    s_mul_i32 s71, s70, 3072
    s_lshl_b32 s68, s69, 9
    s_add_u32 s71, s71, s68
    v_lshl_add_u32 v58, v1, 7, s71
    s_mul_i32 s71, s70, 2752
    s_mul_i32 s68, s69, 384
    s_add_u32 s71, s71, s68
    s_add_u32 s71, s71, 2048
    v_lshl_add_u32 v59, v1, 7, s71
    s_mov_b64 exec, 15
    buffer_load_dword v0, v58, s[32:35], 0 offen
    s_mov_b64 exec, 7
    buffer_load_dword v0, v59, s[36:39], 0 offen
    s_mov_b64 exec, -1
    v_mfma_f32_32x32x16_bf16 v[64:79], v[48:51], a[28:31], v[64:79]
    ds_read_b64_tr_b16 v[40:41], v24 offset:0
    ds_read_b64_tr_b16 v[42:43], v24 offset:1024
    ds_read_b128 a[32:35], v18 offset:0
    ds_read_b64_tr_b16 v[44:45], v25 offset:0
    v_mfma_f32_32x32x16_bf16 v[80:95], v[48:51], a[156:159], v[80:95]
    ds_read_b64_tr_b16 v[46:47], v25 offset:1024
    ds_read_b128 a[160:163], v18 offset:4096
    v_mfma_f32_32x32x16_bf16 v[96:111], a[28:31], v[52:55], v[96:111]
    s_add_u32 m0, s73, 32768
    s_add_u32 s66, s59, 4
    s_and_b32 s66, s66, 7
    s_lshl_b32 s66, s66, 7
    buffer_load_dwordx4 v2, s[28:31], s66 offen offset:0 lds
    v_mfma_f32_32x32x16_bf16 v[112:127], a[156:159], v[52:55], v[112:127]
    buffer_load_dwordx4 v3, s[28:31], s66 offen offset:1024 lds
    s_waitcnt lgkmcnt(0)
    v_mfma_f32_32x32x16_bf16 v[64:79], v[40:43], a[32:35], v[64:79]
    ds_read_b64_tr_b16 v[48:49], v24 offset:4096
    ds_read_b64_tr_b16 v[50:51], v24 offset:5120
    ds_read_b128 a[36:39], v19 offset:0
    ds_read_b64_tr_b16 v[52:53], v25 offset:4096
    v_mfma_f32_32x32x16_bf16 v[80:95], v[40:43], a[160:163], v[80:95]
    ds_read_b64_tr_b16 v[54:55], v25 offset:5120
    ds_read_b128 a[164:167], v19 offset:4096
    v_mfma_f32_32x32x16_bf16 v[96:111], a[32:35], v[44:47], v[96:111]
    buffer_load_dwordx4 v4, s[28:31], s66 offen offset:2048 lds
    v_mfma_f32_32x32x16_bf16 v[112:127], a[160:163], v[44:47], v[112:127]
    buffer_load_dwordx4 v5, s[28:31], s66 offen offset:3072 lds
    s_waitcnt lgkmcnt(0)
    v_mfma_f32_32x32x16_bf16 v[64:79], v[48:51], a[36:39], v[64:79]
    ds_read_b64_tr_b16 v[40:41], v24 offset:8192
    ds_read_b64_tr_b16 v[42:43], v24 offset:9216
    ds_read_b128 a[40:43], v20 offset:0
    ds_read_b64_tr_b16 v[44:45], v25 offset:8192
    v_mfma_f32_32x32x16_bf16 v[80:95], v[48:51], a[164:167], v[80:95]
    ds_read_b64_tr_b16 v[46:47], v25 offset:9216
    ds_read_b128 a[168:171], v20 offset:4096
    v_mfma_f32_32x32x16_bf16 v[96:111], a[36:39], v[52:55], v[96:111]
    s_lshr_b32 s67, s66, 7
    s_add_u32 m0, s74, 32768
    s_mul_i32 s67, s67, s85
    buffer_load_dwordx4 v6, s[32:35], s67 offen offset:0 lds
    v_mfma_f32_32x32x16_bf16 v[112:127], a[164:167], v[52:55], v[112:127]
    buffer_load_dwordx4 v7, s[32:35], s67 offen offset:1024 lds
    s_waitcnt lgkmcnt(0)
    v_mfma_f32_32x32x16_bf16 v[64:79], v[40:43], a[40:43], v[64:79]
    ds_read_b64_tr_b16 v[48:49], v24 offset:12288
    ds_read_b64_tr_b16 v[50:51], v24 offset:13312
    ds_read_b128 a[44:47], v21 offset:0
    ds_read_b64_tr_b16 v[52:53], v25 offset:12288
    v_mfma_f32_32x32x16_bf16 v[80:95], v[40:43], a[168:171], v[80:95]
    ds_read_b64_tr_b16 v[54:55], v25 offset:13312
    ds_read_b128 a[172:175], v21 offset:4096
    v_mfma_f32_32x32x16_bf16 v[96:111], a[40:43], v[44:47], v[96:111]
    buffer_load_dwordx4 v8, s[32:35], s67 offen offset:2048 lds
    v_mfma_f32_32x32x16_bf16 v[112:127], a[168:171], v[44:47], v[112:127]
    buffer_load_dwordx4 v9, s[32:35], s67 offen offset:3072 lds
    s_waitcnt lgkmcnt(0)
    s_waitcnt vmcnt(10)
    s_barrier
    v_mfma_f32_32x32x16_bf16 v[64:79], v[48:51], a[44:47], v[64:79]
    ds_read_b64_tr_b16 v[40:41], v22 offset:0
    ds_read_b64_tr_b16 v[42:43], v22 offset:1024
    ds_read_b128 a[48:51], v14 offset:0
    ds_read_b64_tr_b16 v[44:45], v23 offset:0
    v_mfma_f32_32x32x16_bf16 v[80:95], v[48:51], a[172:175], v[80:95]
    ds_read_b64_tr_b16 v[46:47], v23 offset:1024
    ds_read_b128 a[176:179], v14 offset:4096
    v_mfma_f32_32x32x16_bf16 v[96:111], a[44:47], v[52:55], v[96:111]
    s_add_u32 m0, s73, 65536
    s_add_u32 s66, s59, 5
    s_and_b32 s66, s66, 7
    s_lshl_b32 s66, s66, 7
    buffer_load_dwordx4 v2, s[28:31], s66 offen offset:0 lds
    v_mfma_f32_32x32x16_bf16 v[112:127], a[172:175], v[52:55], v[112:127]
    buffer_load_dwordx4 v3, s[28:31], s66 offen offset:1024 lds
    s_waitcnt lgkmcnt(0)
    v_mfma_f32_32x32x16_bf16 v[64:79], v[40:43], a[48:51], v[64:79]
    ds_read_b64_tr_b16 v[48:49], v22 offset:4096
    ds_read_b64_tr_b16 v[50:51], v22 offset:5120
    ds_read_b128 a[52:55], v15 offset:0
    ds_read_b64_tr_b16 v[52:53], v23 offset:4096
    v_mfma_f32_32x32x16_bf16 v[80:95], v[40:43], a[176:179], v[80:95]
    ds_read_b64_tr_b16 v[54:55], v23 offset:5120
    ds_read_b128 a[180:183], v15 offset:4096
    v_mfma_f32_32x32x16_bf16 v[96:111], a[48:51], v[44:47], v[96:111]
    buffer_load_dwordx4 v4, s[28:31], s66 offen offset:2048 lds
    v_mfma_f32_32x32x16_bf16 v[112:127], a[176:179], v[44:47], v[112:127]
    buffer_load_dwordx4 v5, s[28:31], s66 offen offset:3072 lds
    s_waitcnt lgkmcnt(0)
    v_mfma_f32_32x32x16_bf16 v[64:79], v[48:51], a[52:55], v[64:79]
    ds_read_b64_tr_b16 v[40:41], v22 offset:8192
    ds_read_b64_tr_b16 v[42:43], v22 offset:9216
    ds_read_b128 a[56:59], v16 offset:0
    ds_read_b64_tr_b16 v[44:45], v23 offset:8192
    v_mfma_f32_32x32x16_bf16 v[80:95], v[48:51], a[180:183], v[80:95]
    ds_read_b64_tr_b16 v[46:47], v23 offset:9216
    ds_read_b128 a[184:187], v16 offset:4096
    v_mfma_f32_32x32x16_bf16 v[96:111], a[52:55], v[52:55], v[96:111]
    s_lshr_b32 s67, s66, 7
    s_add_u32 m0, s74, 65536
    s_mul_i32 s67, s67, s85
    buffer_load_dwordx4 v6, s[32:35], s67 offen offset:0 lds
    v_mfma_f32_32x32x16_bf16 v[112:127], a[180:183], v[52:55], v[112:127]
    buffer_load_dwordx4 v7, s[32:35], s67 offen offset:1024 lds
    s_waitcnt lgkmcnt(0)
    v_mfma_f32_32x32x16_bf16 v[64:79], v[40:43], a[56:59], v[64:79]
    ds_read_b64_tr_b16 v[48:49], v22 offset:12288
    ds_read_b64_tr_b16 v[50:51], v22 offset:13312
    ds_read_b128 a[60:63], v17 offset:0
    ds_read_b64_tr_b16 v[52:53], v23 offset:12288
    v_mfma_f32_32x32x16_bf16 v[80:95], v[40:43], a[184:187], v[80:95]
    ds_read_b64_tr_b16 v[54:55], v23 offset:13312
    ds_read_b128 a[188:191], v17 offset:4096
    v_mfma_f32_32x32x16_bf16 v[96:111], a[56:59], v[44:47], v[96:111]
    buffer_load_dwordx4 v8, s[32:35], s67 offen offset:2048 lds
    v_mfma_f32_32x32x16_bf16 v[112:127], a[184:187], v[44:47], v[112:127]
    buffer_load_dwordx4 v9, s[32:35], s67 offen offset:3072 lds
    s_waitcnt lgkmcnt(0)
    s_waitcnt vmcnt(8)
    s_barrier
    v_mov_b32 v56, 0
    global_load_dword v36, v56, s[22:23] sc1
    s_cmp_lg_u32 s58, 6
    s_cbranch_scc1 LKV_nogw3
    s_lshl_b32 s68, s56, 1
    s_add_u32 s69, s68, s59
    s_add_u32 s70, s69, 1
    s_and_b32 s69, s69, 7
    s_and_b32 s70, s70, 7
    s_lshl_b32 s69, s69, 7
    s_lshl_b32 s70, s70, 7
    v_lshl_add_u32 v58, v1, 1, s69
    v_lshl_add_u32 v59, v1, 1, s70
    global_load_ushort v38, v58, s[18:19]
    global_load_ushort v39, v59, s[18:19]
LKV_nogw3:
    v_mfma_f32_32x32x16_bf16 v[64:79], v[48:51], a[60:63], v[64:79]
    ds_read_b64_tr_b16 v[40:41], v22 offset:32768
    ds_read_b64_tr_b16 v[42:43], v22 offset:33792
    ds_read_b128 a[64:67], v14 offset:32768
    ds_read_b64_tr_b16 v[128:129], v23 offset:32768
    v_mfma_f32_32x32x16_bf16 v[80:95], v[48:51], a[188:191], v[80:95]
    ds_read_b64_tr_b16 v[130:131], v23 offset:33792
    ds_read_b128 a[192:195], v14 offset:36864
    v_mfma_f32_32x32x16_bf16 v[96:111], a[60:63], v[52:55], v[96:111]
    s_add_u32 m0, s73, 0
    s_add_u32 s66, s59, 6
    s_and_b32 s66, s66, 7
    s_lshl_b32 s66, s66, 7
    buffer_load_dwordx4 v2, s[28:31], s66 offen offset:0 lds
    v_mfma_f32_32x32x16_bf16 v[112:127], a[188:191], v[52:55], v[112:127]
    buffer_load_dwordx4 v3, s[28:31], s66 offen offset:1024 lds
    s_waitcnt lgkmcnt(0)
    v_mfma_f32_32x32x16_bf16 v[64:79], v[40:43], a[64:67], v[64:79]
    ds_read_b64_tr_b16 v[48:49], v22 offset:36864
    ds_read_b64_tr_b16 v[50:51], v22 offset:37888
    ds_read_b128 a[68:71], v15 offset:32768
    ds_read_b64_tr_b16 v[132:133], v23 offset:36864
    v_mfma_f32_32x32x16_bf16 v[80:95], v[40:43], a[192:195], v[80:95]
    ds_read_b64_tr_b16 v[134:135], v23 offset:37888
    ds_read_b128 a[196:199], v15 offset:36864
    buffer_load_dwordx4 v4, s[28:31], s66 offen offset:2048 lds
    buffer_load_dwordx4 v5, s[28:31], s66 offen offset:3072 lds
    s_waitcnt lgkmcnt(0)
    v_mfma_f32_32x32x16_bf16 v[64:79], v[48:51], a[68:71], v[64:79]
    ds_read_b64_tr_b16 v[40:41], v22 offset:40960
    ds_read_b64_tr_b16 v[42:43], v22 offset:41984
    ds_read_b128 a[72:75], v16 offset:32768
    ds_read_b64_tr_b16 v[136:137], v23 offset:40960
    v_mfma_f32_32x32x16_bf16 v[80:95], v[48:51], a[196:199], v[80:95]
    ds_read_b64_tr_b16 v[138:139], v23 offset:41984
    ds_read_b128 a[200:203], v16 offset:36864
    s_lshr_b32 s67, s66, 7
    s_add_u32 m0, s74, 0
    s_mul_i32 s67, s67, s85
    buffer_load_dwordx4 v6, s[32:35], s67 offen offset:0 lds
    buffer_load_dwordx4 v7, s[32:35], s67 offen offset:1024 lds
    s_waitcnt lgkmcnt(0)
    v_mfma_f32_32x32x16_bf16 v[64:79], v[40:43], a[72:75], v[64:79]
    ds_read_b64_tr_b16 v[48:49], v22 offset:45056
    ds_read_b64_tr_b16 v[50:51], v22 offset:46080
    ds_read_b128 a[76:79], v17 offset:32768
    ds_read_b64_tr_b16 v[140:141], v23 offset:45056
    v_mfma_f32_32x32x16_bf16 v[80:95], v[40:43], a[200:203], v[80:95]
    ds_read_b64_tr_b16 v[142:143], v23 offset:46080
    ds_read_b128 a[204:207], v17 offset:36864
    buffer_load_dwordx4 v8, s[32:35], s67 offen offset:2048 lds
    buffer_load_dwordx4 v9, s[32:35], s67 offen offset:3072 lds
    s_waitcnt lgkmcnt(0)
    s_waitcnt vmcnt(9)
    s_barrier
    v_mfma_f32_32x32x16_bf16 v[64:79], v[48:51], a[76:79], v[64:79]
    ds_read_b64_tr_b16 v[40:41], v24 offset:0
    ds_read_b64_tr_b16 v[42:43], v24 offset:1024
    ds_read_b128 a[80:83], v18 offset:0
    ds_read_b64_tr_b16 v[240:241], v25 offset:0
    v_mfma_f32_32x32x16_bf16 v[80:95], v[48:51], a[204:207], v[80:95]
    ds_read_b64_tr_b16 v[242:243], v25 offset:1024
    ds_read_b128 a[208:211], v18 offset:4096
    s_add_u32 m0, s73, 32768
    s_add_u32 s66, s59, 7
    s_and_b32 s66, s66, 7
    s_lshl_b32 s66, s66, 7
    buffer_load_dwordx4 v2, s[28:31], s66 offen offset:0 lds
    buffer_load_dwordx4 v3, s[28:31], s66 offen offset:1024 lds
    s_waitcnt lgkmcnt(0)
    v_mfma_f32_32x32x16_bf16 v[64:79], v[40:43], a[80:83], v[64:79]
    ds_read_b64_tr_b16 v[48:49], v24 offset:4096
    ds_read_b64_tr_b16 v[50:51], v24 offset:5120
    ds_read_b128 a[84:87], v19 offset:0
    ds_read_b64_tr_b16 v[244:245], v25 offset:4096
    v_mfma_f32_32x32x16_bf16 v[80:95], v[40:43], a[208:211], v[80:95]
    ds_read_b64_tr_b16 v[246:247], v25 offset:5120
    ds_read_b128 a[212:215], v19 offset:4096
    buffer_load_dwordx4 v4, s[28:31], s66 offen offset:2048 lds
    buffer_load_dwordx4 v5, s[28:31], s66 offen offset:3072 lds
    s_waitcnt lgkmcnt(0)
    v_mfma_f32_32x32x16_bf16 v[64:79], v[48:51], a[84:87], v[64:79]
    ds_read_b64_tr_b16 v[40:41], v24 offset:8192
    ds_read_b64_tr_b16 v[42:43], v24 offset:9216
    ds_read_b128 a[88:91], v20 offset:0
    ds_read_b64_tr_b16 v[248:249], v25 offset:8192
    v_mfma_f32_32x32x16_bf16 v[80:95], v[48:51], a[212:215], v[80:95]
    ds_read_b64_tr_b16 v[250:251], v25 offset:9216
    ds_read_b128 a[216:219], v20 offset:4096
    s_lshr_b32 s67, s66, 7
    s_add_u32 m0, s74, 32768
    s_mul_i32 s67, s67, s85
    buffer_load_dwordx4 v6, s[32:35], s67 offen offset:0 lds
    buffer_load_dwordx4 v7, s[32:35], s67 offen offset:1024 lds
    s_waitcnt lgkmcnt(0)
    v_mfma_f32_32x32x16_bf16 v[64:79], v[40:43], a[88:91], v[64:79]
    ds_read_b64_tr_b16 v[48:49], v24 offset:12288
    ds_read_b64_tr_b16 v[50:51], v24 offset:13312
    ds_read_b128 a[92:95], v21 offset:0
    ds_read_b64_tr_b16 v[252:253], v25 offset:12288
    v_mfma_f32_32x32x16_bf16 v[80:95], v[40:43], a[216:219], v[80:95]
    ds_read_b64_tr_b16 v[254:255], v25 offset:13312
    ds_read_b128 a[220:223], v21 offset:4096
    buffer_load_dwordx4 v8, s[32:35], s67 offen offset:2048 lds
    buffer_load_dwordx4 v9, s[32:35], s67 offen offset:3072 lds
    s_lshl_b32 s69, s58, 8
    s_add_u32 s27, s69, 10518528
    s_waitcnt vmcnt(16)
    v_readfirstlane_b32 s64, v36
    s_nop 3
    s_cmp_lg_u32 s64, 0
    s_cbranch_scc0 LKV_nd6_ool1
LKV_nd6:
    s_xor_b32 s68, s57, 10
    s_or_b32 s68, s68, s56
    s_cmp_lg_u32 s68, 0
    s_cbranch_scc1 LKV_nz24
    v_mov_b32 v62, 0
    v_mov_b32 v63, s64
    s_mov_b64 exec, 1
    buffer_store_dword v63, v62, s[48:51], s27 offen sc1
    s_mov_b64 exec, -1
LKV_nz24:
    s_waitcnt lgkmcnt(0)
    s_waitcnt vmcnt(8)
    s_barrier
    v_mfma_f32_32x32x16_bf16 v[64:79], v[48:51], a[92:95], v[64:79]
    ds_read_b64_tr_b16 v[40:41], v22 offset:0
    ds_read_b64_tr_b16 v[42:43], v22 offset:1024
    ds_read_b128 a[96:99], v14 offset:0
    ds_read_b64_tr_b16 v[144:145], v23 offset:0
    v_mfma_f32_32x32x16_bf16 v[80:95], v[48:51], a[220:223], v[80:95]
    ds_read_b64_tr_b16 v[146:147], v23 offset:1024
    ds_read_b128 a[224:227], v14 offset:4096
    s_add_u32 m0, s75, 0
    s_add_u32 s68, s59, 0
    s_and_b32 s68, s68, 7
    s_mul_i32 s67, s68, 176128
    buffer_load_dwordx4 v10, s[36:39], s67 offen offset:0 lds
    buffer_load_dwordx4 v11, s[36:39], s67 offen offset:1024 lds
    s_waitcnt lgkmcnt(0)
    v_mfma_f32_32x32x16_bf16 v[64:79], v[40:43], a[96:99], v[64:79]
    ds_read_b64_tr_b16 v[48:49], v22 offset:4096
    ds_read_b64_tr_b16 v[50:51], v22 offset:5120
    ds_read_b128 a[100:103], v15 offset:0
    ds_read_b64_tr_b16 v[148:149], v23 offset:4096
    v_mfma_f32_32x32x16_bf16 v[80:95], v[40:43], a[224:227], v[80:95]
    ds_read_b64_tr_b16 v[150:151], v23 offset:5120
    ds_read_b128 a[228:231], v15 offset:4096
    s_add_u32 m0, s75, 8192
    s_add_u32 s68, s59, 1
    s_and_b32 s68, s68, 7
    s_mul_i32 s67, s68, 176128
    buffer_load_dwordx4 v10, s[36:39], s67 offen offset:0 lds
    buffer_load_dwordx4 v11, s[36:39], s67 offen offset:1024 lds
    s_waitcnt lgkmcnt(0)
    v_mfma_f32_32x32x16_bf16 v[64:79], v[48:51], a[100:103], v[64:79]
    ds_read_b64_tr_b16 v[40:41], v22 offset:8192
    ds_read_b64_tr_b16 v[42:43], v22 offset:9216
    ds_read_b128 a[104:107], v16 offset:0
    ds_read_b64_tr_b16 v[152:153], v23 offset:8192
    v_mfma_f32_32x32x16_bf16 v[80:95], v[48:51], a[228:231], v[80:95]
    ds_read_b64_tr_b16 v[154:155], v23 offset:9216
    ds_read_b128 a[232:235], v16 offset:4096
    s_add_u32 m0, s75, 16384
    s_add_u32 s68, s59, 2
    s_and_b32 s68, s68, 7
    s_mul_i32 s67, s68, 176128
    buffer_load_dwordx4 v10, s[36:39], s67 offen offset:0 lds
    buffer_load_dwordx4 v11, s[36:39], s67 offen offset:1024 lds
    s_waitcnt lgkmcnt(0)
    v_mfma_f32_32x32x16_bf16 v[64:79], v[40:43], a[104:107], v[64:79]
    ds_read_b64_tr_b16 v[48:49], v22 offset:12288
    ds_read_b64_tr_b16 v[50:51], v22 offset:13312
    ds_read_b128 a[108:111], v17 offset:0
    ds_read_b64_tr_b16 v[156:157], v23 offset:12288
    v_mfma_f32_32x32x16_bf16 v[80:95], v[40:43], a[232:235], v[80:95]
    ds_read_b64_tr_b16 v[158:159], v23 offset:13312
    ds_read_b128 a[236:239], v17 offset:4096
    s_add_u32 m0, s75, 24576
    s_add_u32 s68, s59, 3
    s_and_b32 s68, s68, 7
    s_mul_i32 s67, s68, 176128
    buffer_load_dwordx4 v10, s[36:39], s67 offen offset:0 lds
    buffer_load_dwordx4 v11, s[36:39], s67 offen offset:1024 lds
    s_waitcnt lgkmcnt(0)
    s_waitcnt vmcnt(8)
    s_barrier
    v_mfma_f32_32x32x16_bf16 v[64:79], v[48:51], a[108:111], v[64:79]
    ds_read_b64_tr_b16 v[40:41], v22 offset:32768
    ds_read_b64_tr_b16 v[42:43], v22 offset:33792
    ds_read_b128 a[112:115], v14 offset:32768
    ds_read_b64_tr_b16 v[192:193], v23 offset:32768
    v_mfma_f32_32x32x16_bf16 v[80:95], v[48:51], a[236:239], v[80:95]
    ds_read_b64_tr_b16 v[194:195], v23 offset:33792
    ds_read_b128 a[240:243], v14 offset:36864
    s_waitcnt lgkmcnt(0)
    v_mfma_f32_32x32x16_bf16 v[64:79], v[40:43], a[112:115], v[64:79]
    ds_read_b64_tr_b16 v[48:49], v22 offset:36864
    ds_read_b64_tr_b16 v[50:51], v22 offset:37888
    ds_read_b128 a[116:119], v15 offset:32768
    ds_read_b64_tr_b16 v[196:197], v23 offset:36864
    v_mfma_f32_32x32x16_bf16 v[80:95], v[40:43], a[240:243], v[80:95]
    ds_read_b64_tr_b16 v[198:199], v23 offset:37888
    ds_read_b128 a[244:247], v15 offset:36864
    s_waitcnt lgkmcnt(0)
    v_mfma_f32_32x32x16_bf16 v[64:79], v[48:51], a[116:119], v[64:79]
    ds_read_b64_tr_b16 v[40:41], v22 offset:40960
    ds_read_b64_tr_b16 v[42:43], v22 offset:41984
    ds_read_b128 a[120:123], v16 offset:32768
    ds_read_b64_tr_b16 v[200:201], v23 offset:40960
    v_mfma_f32_32x32x16_bf16 v[80:95], v[48:51], a[244:247], v[80:95]
    ds_read_b64_tr_b16 v[202:203], v23 offset:41984
    ds_read_b128 a[248:251], v16 offset:36864
    s_waitcnt lgkmcnt(0)
    v_mfma_f32_32x32x16_bf16 v[64:79], v[40:43], a[120:123], v[64:79]
    ds_read_b64_tr_b16 v[48:49], v22 offset:45056
    ds_read_b64_tr_b16 v[50:51], v22 offset:46080
    ds_read_b128 a[124:127], v17 offset:32768
    ds_read_b64_tr_b16 v[204:205], v23 offset:45056
    v_mfma_f32_32x32x16_bf16 v[80:95], v[40:43], a[248:251], v[80:95]
    ds_read_b64_tr_b16 v[206:207], v23 offset:46080
    ds_read_b128 a[252:255], v17 offset:36864
    s_waitcnt lgkmcnt(0)
    s_barrier
    v_mfma_f32_32x32x16_bf16 v[64:79], v[48:51], a[124:127], v[64:79]
    v_mfma_f32_32x32x16_bf16 v[80:95], v[48:51], a[252:255], v[80:95]
    s_nop 10
    v_cvt_pk_bf16_f32 v224, v64, v65
    v_cvt_pk_bf16_f32 v225, v66, v67
    v_cvt_pk_bf16_f32 v226, v68, v69
    v_cvt_pk_bf16_f32 v227, v70, v71
    v_cvt_pk_bf16_f32 v228, v72, v73
    v_cvt_pk_bf16_f32 v229, v74, v75
    v_cvt_pk_bf16_f32 v230, v76, v77
    v_cvt_pk_bf16_f32 v231, v78, v79
    v_cvt_pk_bf16_f32 v232, v80, v81
    s_add_u32 m0, s76, 0
    s_nop 0
    buffer_load_dwordx4 v12, s[40:43], s81 offen lds
    buffer_load_dwordx4 v13, s[40:43], s81 offen offset:1024 lds
    v_cvt_pk_bf16_f32 v233, v82, v83
    v_cvt_pk_bf16_f32 v234, v84, v85
    v_cvt_pk_bf16_f32 v235, v86, v87
    v_cvt_pk_bf16_f32 v236, v88, v89
    v_cvt_pk_bf16_f32 v237, v90, v91
    v_cvt_pk_bf16_f32 v238, v92, v93
    v_cvt_pk_bf16_f32 v239, v94, v95
    v_mfma_f32_32x32x16_bf16 v[160:175], v[216:219], v[224:227], 0
    v_mfma_f32_32x32x16_bf16 v[176:191], v[220:223], v[228:231], 0
    v_mfma_f32_32x32x16_bf16 v[96:111], a[64:67], v[128:131], v[96:111]
    v_mfma_f32_32x32x16_bf16 v[112:127], a[192:195], v[128:131], v[112:127]
    v_mfma_f32_32x32x16_bf16 v[96:111], a[68:71], v[132:135], v[96:111]
    v_and_b32 v56, 27, v1
    v_mov_b32 v57, 0x3f803f80
    v_cmp_eq_u32 vcc, 0, v56
    s_nop 1
    v_cndmask_b32 v60, 0, v57, vcc
    v_cndmask_b32 v61, 0, v57, vcc
    v_cndmask_b32 v62, 0, v57, vcc
    v_cndmask_b32 v63, 0, v57, vcc
    v_mov_b32 v35, 0
    v_mfma_f32_32x32x16_bf16 v[112:127], a[196:199], v[132:135], v[112:127]
    v_max3_f32 v56, v160, v161, v162
    v_max3_f32 v57, v163, v164, v165
    v_max3_f32 v56, v56, v166, v167
    v_max3_f32 v57, v57, v168, v169
    v_max3_f32 v56, v56, v170, v171
    v_max3_f32 v57, v57, v172, v173
    s_add_u32 m0, s75, 32768
    s_add_u32 s68, s59, 4
    s_and_b32 s68, s68, 7
    s_mul_i32 s67, s68, 176128
    buffer_load_dwordx4 v10, s[36:39], s67 offen offset:0 lds
    buffer_load_dwordx4 v11, s[36:39], s67 offen offset:1024 lds
    v_max3_f32 v56, v56, v174, v175
    v_mfma_f32_32x32x16_bf16 v[96:111], a[72:75], v[136:139], v[96:111]
    v_max_f32 v56, v56, v57
    v_mul_f32_e64 v56, -v56, s98
    v_fma_f32 v160, v160, s98, v56
    v_fma_f32 v161, v161, s98, v56
    v_fma_f32 v162, v162, s98, v56
    v_fma_f32 v163, v163, s98, v56
    v_mfma_f32_32x32x16_bf16 v[112:127], a[200:203], v[136:139], v[112:127]
    v_fma_f32 v164, v164, s98, v56
    v_fma_f32 v165, v165, s98, v56
    v_fma_f32 v166, v166, s98, v56
    v_fma_f32 v167, v167, s98, v56
    v_fma_f32 v168, v168, s98, v56
    v_fma_f32 v169, v169, s98, v56
    v_mfma_f32_32x32x16_bf16 v[96:111], a[76:79], v[140:143], v[96:111]
    v_fma_f32 v170, v170, s98, v56
    v_fma_f32 v171, v171, s98, v56
    v_fma_f32 v172, v172, s98, v56
    v_fma_f32 v173, v173, s98, v56
    v_fma_f32 v174, v174, s98, v56
    v_fma_f32 v175, v175, s98, v56
    v_mfma_f32_32x32x16_bf16 v[112:127], a[204:207], v[140:143], v[112:127]
    v_exp_f32 v160, v160
    v_exp_f32 v161, v161
    v_exp_f32 v162, v162
    v_exp_f32 v163, v163
    s_add_u32 m0, s76, 2048
    s_add_u32 s81, s81, 16384
    s_and_b32 s81, s81, 262143
    buffer_load_dwordx4 v12, s[40:43], s81 offen lds
    buffer_load_dwordx4 v13, s[40:43], s81 offen offset:1024 lds
    v_mfma_f32_32x32x16_bf16 v[96:111], a[80:83], v[240:243], v[96:111]
    v_exp_f32 v164, v164
    v_exp_f32 v165, v165
    v_exp_f32 v166, v166
    v_exp_f32 v167, v167
    v_mfma_f32_32x32x16_bf16 v[112:127], a[208:211], v[240:243], v[112:127]
    v_exp_f32 v168, v168
    v_exp_f32 v169, v169
    v_exp_f32 v170, v170
    v_mfma_f32_32x32x16_bf16 v[96:111], a[84:87], v[244:247], v[96:111]
    v_exp_f32 v171, v171
    v_exp_f32 v172, v172
    v_exp_f32 v173, v173
    v_exp_f32 v174, v174
    v_mfma_f32_32x32x16_bf16 v[112:127], a[212:215], v[244:247], v[112:127]
    v_exp_f32 v175, v175
    v_add_f32 v56, v160, v161
    v_add_f32 v57, v162, v163
    v_add_f32 v56, v56, v164
    v_add_f32 v57, v57, v165
    v_add_f32 v56, v56, v166
    v_add_f32 v57, v57, v167
    v_mfma_f32_32x32x16_bf16 v[96:111], a[88:91], v[248:251], v[96:111]
    v_add_f32 v56, v56, v168
    v_add_f32 v57, v57, v169
    v_add_f32 v56, v56, v170
    v_add_f32 v57, v57, v171
    s_add_u32 m0, s75, 40960
    s_add_u32 s68, s59, 5
    s_and_b32 s68, s68, 7
    s_mul_i32 s67, s68, 176128
    buffer_load_dwordx4 v10, s[36:39], s67 offen offset:0 lds
    buffer_load_dwordx4 v11, s[36:39], s67 offen offset:1024 lds
    v_add_f32 v56, v56, v172
    v_add_f32 v57, v57, v173
    v_add_f32 v56, v56, v174
    v_mfma_f32_32x32x16_bf16 v[112:127], a[216:219], v[248:251], v[112:127]
    v_add_f32 v57, v57, v175
    v_add_f32 v56, v56, v57
    v_rcp_f32 v56, v56
    s_nop 0
    v_mul_f32 v160, v56, v160
    v_mul_f32 v161, v56, v161
    v_mul_f32 v162, v56, v162
    v_mul_f32 v163, v56, v163
    v_mfma_f32_32x32x16_bf16 v[96:111], a[92:95], v[252:255], v[96:111]
    v_mul_f32 v164, v56, v164
    v_mul_f32 v165, v56, v165
    v_mul_f32 v166, v56, v166
    v_mul_f32 v167, v56, v167
    v_mul_f32 v168, v56, v168
    v_mul_f32 v169, v56, v169
    v_mul_f32 v170, v56, v170
    v_mfma_f32_32x32x16_bf16 v[112:127], a[220:223], v[252:255], v[112:127]
    v_mul_f32 v171, v56, v171
    v_mul_f32 v172, v56, v172
    v_mul_f32 v173, v56, v173
    v_mul_f32 v174, v56, v174
    v_mul_f32 v175, v56, v175
    v_cvt_pk_bf16_f32 v160, v160, v161
    v_cvt_pk_bf16_f32 v161, v162, v163
    s_add_u32 m0, s76, 4096
    s_add_u32 s81, s81, 16384
    s_and_b32 s81, s81, 262143
    buffer_load_dwordx4 v12, s[40:43], s81 offen lds
    buffer_load_dwordx4 v13, s[40:43], s81 offen offset:1024 lds
    v_mfma_f32_32x32x16_bf16 v[96:111], a[96:99], v[144:147], v[96:111]
    v_cvt_pk_bf16_f32 v162, v164, v165
    v_cvt_pk_bf16_f32 v163, v166, v167
    v_cvt_pk_bf16_f32 v164, v168, v169
    v_cvt_pk_bf16_f32 v165, v170, v171
    v_cvt_pk_bf16_f32 v166, v172, v173
    v_cvt_pk_bf16_f32 v167, v174, v175
    v_mfma_f32_32x32x16_bf16 v[128:143], v[160:163], v[208:211], 0
    s_nop 0
    v_mfma_f32_32x32x16_bf16 v[128:143], v[164:167], v[212:215], v[128:143]
    v_mfma_f32_32x32x16_bf16 v[160:175], v[220:223], v[236:239], 0
    buffer_load_dword v36, v35, s[48:51], s27 offen offset:0 sc1
    v_mfma_f32_32x32x16_bf16 v[112:127], a[224:227], v[144:147], v[112:127]
    v_max3_f32 v56, v176, v177, v178
    v_max3_f32 v57, v179, v180, v181
    v_max3_f32 v56, v56, v182, v183
    v_max3_f32 v57, v57, v184, v185
    v_max3_f32 v56, v56, v186, v187
    v_max3_f32 v57, v57, v188, v189
    v_max3_f32 v56, v56, v190, v191
    v_mfma_f32_32x32x16_bf16 v[96:111], a[100:103], v[148:151], v[96:111]
    v_max_f32 v56, v56, v57
    v_mul_f32_e64 v56, -v56, s98
    v_fma_f32 v176, v176, s98, v56
    v_fma_f32 v177, v177, s98, v56
    v_fma_f32 v178, v178, s98, v56
    v_fma_f32 v179, v179, s98, v56
    v_mfma_f32_32x32x16_bf16 v[112:127], a[228:231], v[148:151], v[112:127]
    s_add_u32 m0, s75, 49152
    s_add_u32 s68, s59, 6
    s_and_b32 s68, s68, 7
    s_mul_i32 s67, s68, 176128
    buffer_load_dwordx4 v10, s[36:39], s67 offen offset:0 lds
    buffer_load_dwordx4 v11, s[36:39], s67 offen offset:1024 lds
    v_fma_f32 v180, v180, s98, v56
    v_fma_f32 v181, v181, s98, v56
    v_fma_f32 v182, v182, s98, v56
    v_fma_f32 v183, v183, s98, v56
    v_fma_f32 v184, v184, s98, v56
    v_fma_f32 v185, v185, s98, v56
    v_mfma_f32_32x32x16_bf16 v[96:111], a[104:107], v[152:155], v[96:111]
    v_fma_f32 v186, v186, s98, v56
    v_fma_f32 v187, v187, s98, v56
    v_fma_f32 v188, v188, s98, v56
    v_fma_f32 v189, v189, s98, v56
    v_fma_f32 v190, v190, s98, v56
    v_fma_f32 v191, v191, s98, v56
    v_mfma_f32_32x32x16_bf16 v[112:127], a[232:235], v[152:155], v[112:127]
    v_exp_f32 v176, v176
    v_exp_f32 v177, v177
    v_exp_f32 v178, v178
    v_exp_f32 v179, v179
    v_mfma_f32_32x32x16_bf16 v[96:111], a[108:111], v[156:159], v[96:111]
    v_exp_f32 v180, v180
    v_exp_f32 v181, v181
    v_exp_f32 v182, v182
    v_exp_f32 v183, v183
    v_mfma_f32_32x32x16_bf16 v[112:127], a[236:239], v[156:159], v[112:127]
    v_exp_f32 v184, v184
    v_exp_f32 v185, v185
    v_exp_f32 v186, v186
    s_add_u32 m0, s76, 6144
    s_add_u32 s81, s81, 16384
    s_and_b32 s81, s81, 262143
    buffer_load_dwordx4 v12, s[40:43], s81 offen lds
    buffer_load_dwordx4 v13, s[40:43], s81 offen offset:1024 lds
    v_exp_f32 v187, v187
    v_mfma_f32_32x32x16_bf16 v[96:111], a[112:115], v[192:195], v[96:111]
    v_exp_f32 v188, v188
    v_exp_f32 v189, v189
    v_exp_f32 v190, v190
    v_exp_f32 v191, v191
    v_mfma_f32_32x32x16_bf16 v[112:127], a[240:243], v[192:195], v[112:127]
    v_add_f32 v56, v176, v177
    v_add_f32 v57, v178, v179
    v_add_f32 v56, v56, v180
    v_add_f32 v57, v57, v181
    v_add_f32 v56, v56, v182
    v_add_f32 v57, v57, v183
    v_add_f32 v56, v56, v184
    v_mfma_f32_32x32x16_bf16 v[96:111], a[116:119], v[196:199], v[96:111]
    v_add_f32 v57, v57, v185
    v_add_f32 v56, v56, v186
    v_add_f32 v57, v57, v187
    v_add_f32 v56, v56, v188
    v_add_f32 v57, v57, v189
    v_add_f32 v56, v56, v190
    v_add_f32 v57, v57, v191
    v_add_f32 v56, v56, v57
    v_mfma_f32_32x32x16_bf16 v[112:127], a[244:247], v[196:199], v[112:127]
    v_rcp_f32 v56, v56
    s_nop 0
    v_mul_f32 v176, v56, v176
    v_mul_f32 v177, v56, v177
    s_add_u32 m0, s75, 57344
    s_add_u32 s68, s59, 7
    s_and_b32 s68, s68, 7
    s_mul_i32 s67, s68, 176128
    buffer_load_dwordx4 v10, s[36:39], s67 offen offset:0 lds
    buffer_load_dwordx4 v11, s[36:39], s67 offen offset:1024 lds
    v_mul_f32 v178, v56, v178
    v_mul_f32 v179, v56, v179
    v_mul_f32 v180, v56, v180
    v_mul_f32 v181, v56, v181
    v_mfma_f32_32x32x16_bf16 v[96:111], a[120:123], v[200:203], v[96:111]
    v_mul_f32 v182, v56, v182
    v_mul_f32 v183, v56, v183
    v_mul_f32 v184, v56, v184
    v_mul_f32 v185, v56, v185
    v_mul_f32 v186, v56, v186
    v_mul_f32 v187, v56, v187
    v_mul_f32 v188, v56, v188
    v_mfma_f32_32x32x16_bf16 v[112:127], a[248:251], v[200:203], v[112:127]
    v_mul_f32 v189, v56, v189
    v_mul_f32 v190, v56, v190
    v_mul_f32 v191, v56, v191
    v_cvt_pk_bf16_f32 v176, v176, v177
    v_cvt_pk_bf16_f32 v177, v178, v179
    v_cvt_pk_bf16_f32 v178, v180, v181
    v_cvt_pk_bf16_f32 v179, v182, v183
    v_mfma_f32_32x32x16_bf16 v[96:111], a[124:127], v[204:207], v[96:111]
    v_cvt_pk_bf16_f32 v180, v184, v185
    v_cvt_pk_bf16_f32 v181, v186, v187
    v_cvt_pk_bf16_f32 v182, v188, v189
    v_cvt_pk_bf16_f32 v183, v190, v191
    v_cvt_pk_bf16_f32 v128, v128, v129
    v_cvt_pk_bf16_f32 v129, v130, v131
    s_add_u32 m0, s76, 8192
    s_add_u32 s81, s81, 16384
    s_and_b32 s81, s81, 262143
    buffer_load_dwordx4 v12, s[40:43], s81 offen lds
    buffer_load_dwordx4 v13, s[40:43], s81 offen offset:1024 lds
    v_mfma_f32_32x32x16_bf16 v[112:127], a[252:255], v[204:207], v[112:127]
    v_cvt_pk_bf16_f32 v130, v132, v133
    v_cvt_pk_bf16_f32 v131, v134, v135
    v_cvt_pk_bf16_f32 v132, v136, v137
    v_cvt_pk_bf16_f32 v133, v138, v139
    v_cvt_pk_bf16_f32 v134, v140, v141
    v_cvt_pk_bf16_f32 v135, v142, v143
    v_mfma_f32_32x32x16_bf16 v[144:159], v[176:179], v[208:211], 0
    v_mfma_f32_32x32x16_bf16 v[144:159], v[180:183], v[212:215], v[144:159]
    v_mfma_f32_32x32x16_bf16 v[192:207], v[216:219], v[232:235], 0
    v_cvt_pk_bf16_f32 v240, v96, v97
    v_cvt_pk_bf16_f32 v241, v98, v99
    v_cvt_pk_bf16_f32 v242, v100, v101
    v_cvt_pk_bf16_f32 v243, v102, v103
    v_cvt_pk_bf16_f32 v244, v104, v105
    v_cvt_pk_bf16_f32 v245, v106, v107
    v_cvt_pk_bf16_f32 v246, v108, v109
    v_cvt_pk_bf16_f32 v247, v110, v111
    v_cvt_pk_bf16_f32 v248, v112, v113
    v_cvt_pk_bf16_f32 v249, v114, v115
    v_cvt_pk_bf16_f32 v250, v116, v117
    v_cvt_pk_bf16_f32 v251, v118, v119
    v_cvt_pk_bf16_f32 v252, v120, v121
    v_cvt_pk_bf16_f32 v253, v122, v123
    v_cvt_pk_bf16_f32 v254, v124, v125
    v_cvt_pk_bf16_f32 v255, v126, v127
    v_mfma_f32_32x32x16_bf16 v[64:79], v[128:131], v[240:243], 0
    s_add_u32 m0, s76, 10240
    s_add_u32 s81, s81, 16384
    s_and_b32 s81, s81, 262143
    buffer_load_dwordx4 v12, s[40:43], s81 offen lds
    buffer_load_dwordx4 v13, s[40:43], s81 offen offset:1024 lds
    v_mfma_f32_32x32x16_bf16 v[64:79], v[132:135], v[244:247], v[64:79]
    v_mfma_f32_32x32x16_bf16 v[96:111], v[60:63], v[128:131], 0
    v_mfma_f32_32x32x16_bf16 v[96:111], v[60:63], v[132:135], v[96:111]
    v_max3_f32 v56, v192, v193, v194
    v_max3_f32 v57, v195, v196, v197
    v_max3_f32 v56, v56, v198, v199
    v_max3_f32 v57, v57, v200, v201
    v_max3_f32 v56, v56, v202, v203
    v_max3_f32 v57, v57, v204, v205
    v_max3_f32 v56, v56, v206, v207
    v_max_f32 v56, v56, v57
    v_mul_f32_e64 v56, -v56, s98
    v_cvt_pk_bf16_f32 v144, v144, v145
    v_cvt_pk_bf16_f32 v145, v146, v147
    v_cvt_pk_bf16_f32 v146, v148, v149
    v_cvt_pk_bf16_f32 v147, v150, v151
    v_cvt_pk_bf16_f32 v148, v152, v153
    v_cvt_pk_bf16_f32 v149, v154, v155
    v_cvt_pk_bf16_f32 v150, v156, v157
    v_cvt_pk_bf16_f32 v151, v158, v159
    v_pk_fma_f32 v[192:193], v[192:193], s[98:99], v[56:57] op_sel_hi:[1,0,0]
    v_pk_fma_f32 v[194:195], v[194:195], s[98:99], v[56:57] op_sel_hi:[1,0,0]
    v_pk_fma_f32 v[196:197], v[196:197], s[98:99], v[56:57] op_sel_hi:[1,0,0]
    v_pk_fma_f32 v[198:199], v[198:199], s[98:99], v[56:57] op_sel_hi:[1,0,0]
    v_mfma_f32_32x32x16_bf16 v[80:95], v[144:147], v[240:243], 0
    v_pk_fma_f32 v[200:201], v[200:201], s[98:99], v[56:57] op_sel_hi:[1,0,0]
    v_pk_fma_f32 v[202:203], v[202:203], s[98:99], v[56:57] op_sel_hi:[1,0,0]
    s_add_u32 m0, s76, 12288
    s_add_u32 s81, s81, 16384
    s_and_b32 s81, s81, 262143
    buffer_load_dwordx4 v12, s[40:43], s81 offen lds
    buffer_load_dwordx4 v13, s[40:43], s81 offen offset:1024 lds
    v_pk_fma_f32 v[204:205], v[204:205], s[98:99], v[56:57] op_sel_hi:[1,0,0]
    v_pk_fma_f32 v[206:207], v[206:207], s[98:99], v[56:57] op_sel_hi:[1,0,0]
    v_exp_f32 v192, v192
    v_exp_f32 v193, v193
    v_mfma_f32_32x32x16_bf16 v[80:95], v[148:151], v[244:247], v[80:95]
    v_exp_f32 v194, v194
    v_exp_f32 v195, v195
    v_exp_f32 v196, v196
    v_exp_f32 v197, v197
    v_exp_f32 v198, v198
    v_mfma_f32_32x32x16_bf16 v[112:127], v[60:63], v[144:147], 0
    v_exp_f32 v199, v199
    v_exp_f32 v200, v200
    v_exp_f32 v201, v201
    v_exp_f32 v202, v202
    v_exp_f32 v203, v203
    v_mfma_f32_32x32x16_bf16 v[112:127], v[60:63], v[148:151], v[112:127]
    v_exp_f32 v204, v204
    v_exp_f32 v205, v205
    v_exp_f32 v206, v206
    v_exp_f32 v207, v207
    v_pk_add_f32 v[56:57], v[192:193], v[194:195]
    v_pk_add_f32 v[58:59], v[196:197], v[198:199]
    v_pk_add_f32 v[56:57], v[56:57], v[200:201]
    v_pk_add_f32 v[58:59], v[58:59], v[202:203]
    v_pk_add_f32 v[56:57], v[56:57], v[204:205]
    v_pk_add_f32 v[58:59], v[58:59], v[206:207]
    s_add_u32 m0, s76, 14336
    s_add_u32 s81, s81, 16384
    s_and_b32 s81, s81, 262143
    buffer_load_dwordx4 v12, s[40:43], s81 offen lds
    buffer_load_dwordx4 v13, s[40:43], s81 offen offset:1024 lds
    v_pk_add_f32 v[56:57], v[56:57], v[58:59]
    v_add_f32 v56, v56, v57
    v_rcp_f32 v56, v56
    s_nop 0
    v_pk_mul_f32 v[192:193], v[192:193], v[56:57] op_sel_hi:[1,0]
    v_pk_mul_f32 v[194:195], v[194:195], v[56:57] op_sel_hi:[1,0]
    v_pk_mul_f32 v[196:197], v[196:197], v[56:57] op_sel_hi:[1,0]
    v_pk_mul_f32 v[198:199], v[198:199], v[56:57] op_sel_hi:[1,0]
    v_pk_mul_f32 v[200:201], v[200:201], v[56:57] op_sel_hi:[1,0]
    v_pk_mul_f32 v[202:203], v[202:203], v[56:57] op_sel_hi:[1,0]
    v_pk_mul_f32 v[204:205], v[204:205], v[56:57] op_sel_hi:[1,0]
    v_pk_mul_f32 v[206:207], v[206:207], v[56:57] op_sel_hi:[1,0]
    v_cvt_pk_bf16_f32 v192, v192, v193
    v_cvt_pk_bf16_f32 v193, v194, v195
    v_cvt_pk_bf16_f32 v194, v196, v197
    v_cvt_pk_bf16_f32 v195, v198, v199
    v_cvt_pk_bf16_f32 v196, v200, v201
    v_cvt_pk_bf16_f32 v197, v202, v203
    v_cvt_pk_bf16_f32 v198, v204, v205
    v_cvt_pk_bf16_f32 v199, v206, v207
    v_mfma_f32_32x32x16_bf16 v[128:143], v[192:195], v[208:211], 0
    s_nop 0
    v_mfma_f32_32x32x16_bf16 v[128:143], v[196:199], v[212:215], v[128:143]
    s_waitcnt vmcnt(14)
    v_cmp_ne_u32 vcc, s64, v36
    s_nop 1
    s_cbranch_vccnz LKV_pdone9_ool2
LKV_pdone9:
    s_add_u32 m0, s76, 16384
    s_add_u32 s81, s81, 16384
    s_and_b32 s81, s81, 262143
    buffer_load_dwordx4 v12, s[40:43], s81 offen lds
    buffer_load_dwordx4 v13, s[40:43], s81 offen offset:1024 lds
    v_max3_f32 v56, v160, v161, v162
    v_max3_f32 v57, v163, v164, v165
    v_max3_f32 v56, v56, v166, v167
    v_max3_f32 v57, v57, v168, v169
    v_max3_f32 v56, v56, v170, v171
    v_max3_f32 v57, v57, v172, v173
    v_max3_f32 v56, v56, v174, v175
    v_max_f32 v56, v56, v57
    v_mul_f32_e64 v56, -v56, s98
    v_cvt_pk_bf16_f32 v128, v128, v129
    v_cvt_pk_bf16_f32 v129, v130, v131
    v_cvt_pk_bf16_f32 v130, v132, v133
    v_cvt_pk_bf16_f32 v131, v134, v135
    v_cvt_pk_bf16_f32 v132, v136, v137
    v_cvt_pk_bf16_f32 v133, v138, v139
    v_cvt_pk_bf16_f32 v134, v140, v141
    v_cvt_pk_bf16_f32 v135, v142, v143
    v_pk_fma_f32 v[160:161], v[160:161], s[98:99], v[56:57] op_sel_hi:[1,0,0]
    v_pk_fma_f32 v[162:163], v[162:163], s[98:99], v[56:57] op_sel_hi:[1,0,0]
    v_pk_fma_f32 v[164:165], v[164:165], s[98:99], v[56:57] op_sel_hi:[1,0,0]
    v_pk_fma_f32 v[166:167], v[166:167], s[98:99], v[56:57] op_sel_hi:[1,0,0]
    v_mfma_f32_32x32x16_bf16 v[64:79], v[128:131], v[248:251], v[64:79]
    v_pk_fma_f32 v[168:169], v[168:169], s[98:99], v[56:57] op_sel_hi:[1,0,0]
    v_pk_fma_f32 v[170:171], v[170:171], s[98:99], v[56:57] op_sel_hi:[1,0,0]
    v_pk_fma_f32 v[172:173], v[172:173], s[98:99], v[56:57] op_sel_hi:[1,0,0]
    v_pk_fma_f32 v[174:175], v[174:175], s[98:99], v[56:57] op_sel_hi:[1,0,0]
    v_exp_f32 v160, v160
    v_exp_f32 v161, v161
    v_mfma_f32_32x32x16_bf16 v[64:79], v[132:135], v[252:255], v[64:79]
    v_exp_f32 v162, v162
    v_exp_f32 v163, v163
    v_exp_f32 v164, v164
    v_exp_f32 v165, v165
    v_exp_f32 v166, v166
    v_mfma_f32_32x32x16_bf16 v[96:111], v[60:63], v[128:131], v[96:111]
    v_exp_f32 v167, v167
    v_exp_f32 v168, v168
    v_exp_f32 v169, v169
    v_exp_f32 v170, v170
    v_exp_f32 v171, v171
    v_mfma_f32_32x32x16_bf16 v[96:111], v[60:63], v[132:135], v[96:111]
    v_exp_f32 v172, v172
    v_exp_f32 v173, v173
    v_exp_f32 v174, v174
    v_exp_f32 v175, v175
    v_pk_add_f32 v[56:57], v[160:161], v[162:163]
    v_pk_add_f32 v[58:59], v[164:165], v[166:167]
    v_pk_add_f32 v[56:57], v[56:57], v[168:169]
    v_pk_add_f32 v[58:59], v[58:59], v[170:171]
    v_pk_add_f32 v[56:57], v[56:57], v[172:173]
    v_pk_add_f32 v[58:59], v[58:59], v[174:175]
    v_pk_add_f32 v[56:57], v[56:57], v[58:59]
    v_add_f32 v56, v56, v57
    v_rcp_f32 v56, v56
    s_nop 0
    v_pk_mul_f32 v[160:161], v[160:161], v[56:57] op_sel_hi:[1,0]
    v_pk_mul_f32 v[162:163], v[162:163], v[56:57] op_sel_hi:[1,0]
    v_pk_mul_f32 v[164:165], v[164:165], v[56:57] op_sel_hi:[1,0]
    v_pk_mul_f32 v[166:167], v[166:167], v[56:57] op_sel_hi:[1,0]
    v_pk_mul_f32 v[168:169], v[168:169], v[56:57] op_sel_hi:[1,0]
    v_pk_mul_f32 v[170:171], v[170:171], v[56:57] op_sel_hi:[1,0]
    v_pk_mul_f32 v[172:173], v[172:173], v[56:57] op_sel_hi:[1,0]
    v_pk_mul_f32 v[174:175], v[174:175], v[56:57] op_sel_hi:[1,0]
    v_cvt_pk_bf16_f32 v160, v160, v161
    v_cvt_pk_bf16_f32 v161, v162, v163
    v_cvt_pk_bf16_f32 v162, v164, v165
    v_cvt_pk_bf16_f32 v163, v166, v167
    v_cvt_pk_bf16_f32 v164, v168, v169
    v_cvt_pk_bf16_f32 v165, v170, v171
    v_cvt_pk_bf16_f32 v166, v172, v173
    v_cvt_pk_bf16_f32 v167, v174, v175
    v_mfma_f32_32x32x16_bf16 v[144:159], v[160:163], v[208:211], 0
    s_nop 0
    v_mfma_f32_32x32x16_bf16 v[144:159], v[164:167], v[212:215], v[144:159]
    s_lshl_b32 s68, s56, 11
    s_add_u32 s68, s68, 90112
    s_xor_b32 s69, s68, 4096
    v_lshl_add_u32 v56, v1, 4, s68
    v_lshl_add_u32 v57, v1, 4, s69
    v_lshrrev_b32 v58, 5, v1
    v_and_b32 v59, 31, v1
    v_lshlrev_b32 v59, 2, v59
    v_lshl_add_u32 v177, v58, 7, v59
    s_lshl_b32 s70, s60, 6
    v_xor_b32 v177, s70, v177
    v_lshl_add_u32 v59, v58, 9, v59
    s_add_u32 s69, s26, 4096
    s_lshl_b32 s70, s60, 11
    s_add_u32 s68, s26, s70
    s_mov_b32 s92, 0
    s_mov_b32 s93, -1
    v_cvt_pk_bf16_f32 v144, v144, v145
    v_cvt_pk_bf16_f32 v145, v146, v147
    v_cvt_pk_bf16_f32 v146, v148, v149
    v_cvt_pk_bf16_f32 v147, v150, v151
    v_cvt_pk_bf16_f32 v148, v152, v153
    v_cvt_pk_bf16_f32 v149, v154, v155
    v_cvt_pk_bf16_f32 v150, v156, v157
    v_cvt_pk_bf16_f32 v151, v158, v159
    v_mfma_f32_32x32x16_bf16 v[80:95], v[144:147], v[248:251], v[80:95]
    s_nop 0
    v_mfma_f32_32x32x16_bf16 v[80:95], v[148:151], v[252:255], v[80:95]
    v_mfma_f32_32x32x16_bf16 v[112:127], v[60:63], v[144:147], v[112:127]
    v_mfma_f32_32x32x16_bf16 v[112:127], v[60:63], v[148:151], v[112:127]
    s_nop 9
    v_cndmask_b32 v168, v72, v88, s[86:87]
    v_cndmask_b32 v169, v73, v89, s[86:87]
    v_cndmask_b32 v170, v74, v90, s[86:87]
    v_cndmask_b32 v171, v75, v91, s[86:87]
    v_cndmask_b32 v172, v76, v92, s[86:87]
    v_cndmask_b32 v173, v77, v93, s[86:87]
    v_cndmask_b32 v174, v78, v94, s[86:87]
    v_cndmask_b32 v175, v79, v95, s[86:87]
    ds_write_b128 v56, v[168:171]
    ds_write_b128 v56, v[172:175] offset:1024
    v_cndmask_b32 v160, v64, v80, s[86:87]
    v_cndmask_b32 v161, v65, v81, s[86:87]
    v_cndmask_b32 v162, v66, v82, s[86:87]
    v_cndmask_b32 v163, v67, v83, s[86:87]
    v_cndmask_b32 v164, v68, v84, s[86:87]
    v_cndmask_b32 v165, v69, v85, s[86:87]
    v_cndmask_b32 v166, v70, v86, s[86:87]
    v_cndmask_b32 v167, v71, v87, s[86:87]
    v_cndmask_b32 v176, v96, v112, s[92:93]
    s_waitcnt vmcnt(10)
    s_waitcnt lgkmcnt(0)
    s_barrier
    ds_read_b128 v[168:171], v57
    ds_read_b128 v[172:175], v57 offset:1024
    buffer_atomic_add_f32 v176, v177, s[48:51], s69 offen
    s_waitcnt lgkmcnt(0)
    v_pk_add_f32 v[160:161], v[160:161], v[168:169]
    v_pk_add_f32 v[162:163], v[162:163], v[170:171]
    v_pk_add_f32 v[164:165], v[164:165], v[172:173]
    v_pk_add_f32 v[166:167], v[166:167], v[174:175]
    buffer_atomic_add_f32 v160, v59, s[48:51], s68 offen offset:0
    buffer_atomic_add_f32 v161, v59, s[48:51], s68 offen offset:128
    buffer_atomic_add_f32 v162, v59, s[48:51], s68 offen offset:256
    buffer_atomic_add_f32 v163, v59, s[48:51], s68 offen offset:384
    buffer_atomic_add_f32 v164, v59, s[48:51], s68 offen offset:1024
    buffer_atomic_add_f32 v165, v59, s[48:51], s68 offen offset:1152
    buffer_atomic_add_f32 v166, v59, s[48:51], s68 offen offset:1280
    buffer_atomic_add_f32 v167, v59, s[48:51], s68 offen offset:1408
    s_cmp_lg_u32 s58, 6
    s_cbranch_scc1 LKV_nogate11
    v_bfe_u32 v58, v1, 1, 1
    v_xor_b32 v58, 1, v58
    v_lshlrev_b32 v58, 6, v58
    v_lshl_add_u32 v58, v1, 7, v58
    v_add_u32 v58, s77, v58
    ds_write_b16 v58, v38
    ds_write_b16 v58, v39 offset:8192
    s_waitcnt lgkmcnt(0)
    s_barrier
LKV_nogate11:
    ds_read_b64_tr_b16 v[40:41], v26 offset:0
    ds_read_b64_tr_b16 v[42:43], v26 offset:512
    ds_read_b64_tr_b16 v[48:49], v26 offset:2048
    ds_read_b64_tr_b16 v[50:51], v26 offset:2560
    s_waitcnt lgkmcnt(2)
    v_mfma_f32_32x32x16_bf16 v[128:143], v[40:43], a[0:3], 0
    v_mfma_f32_32x32x16_bf16 v[144:159], v[40:43], a[128:131], 0
    ds_read_b64_tr_b16 v[40:41], v26 offset:4096
    ds_read_b64_tr_b16 v[42:43], v26 offset:4608
    s_waitcnt lgkmcnt(2)
    v_mfma_f32_32x32x16_bf16 v[128:143], v[48:51], a[4:7], v[128:143]
    s_add_u32 m0, s76, 18432
    s_add_u32 s81, s81, 16384
    s_and_b32 s81, s81, 262143
    buffer_load_dwordx4 v12, s[40:43], s81 offen lds
    buffer_load_dwordx4 v13, s[40:43], s81 offen offset:1024 lds
    v_mfma_f32_32x32x16_bf16 v[144:159], v[48:51], a[132:135], v[144:159]
    ds_read_b64_tr_b16 v[48:49], v26 offset:6144
    ds_read_b64_tr_b16 v[50:51], v26 offset:6656
    s_waitcnt lgkmcnt(2)
    v_mfma_f32_32x32x16_bf16 v[128:143], v[40:43], a[8:11], v[128:143]
    v_mfma_f32_32x32x16_bf16 v[144:159], v[40:43], a[136:139], v[144:159]
    ds_read_b64_tr_b16 v[40:41], v26 offset:8192
    ds_read_b64_tr_b16 v[42:43], v26 offset:8704
    s_waitcnt lgkmcnt(2)
    v_mfma_f32_32x32x16_bf16 v[128:143], v[48:51], a[12:15], v[128:143]
    s_add_u32 m0, s76, 20480
    s_add_u32 s81, s81, 16384
    s_and_b32 s81, s81, 262143
    buffer_load_dwordx4 v12, s[40:43], s81 offen lds
    buffer_load_dwordx4 v13, s[40:43], s81 offen offset:1024 lds
    v_mfma_f32_32x32x16_bf16 v[144:159], v[48:51], a[140:143], v[144:159]
    ds_read_b64_tr_b16 v[48:49], v26 offset:10240
    ds_read_b64_tr_b16 v[50:51], v26 offset:10752
    s_waitcnt lgkmcnt(2)
    v_mfma_f32_32x32x16_bf16 v[128:143], v[40:43], a[16:19], v[128:143]
    v_mfma_f32_32x32x16_bf16 v[144:159], v[40:43], a[144:147], v[144:159]
    ds_read_b64_tr_b16 v[40:41], v26 offset:12288
    ds_read_b64_tr_b16 v[42:43], v26 offset:12800
    s_waitcnt lgkmcnt(2)
    v_mfma_f32_32x32x16_bf16 v[128:143], v[48:51], a[20:23], v[128:143]
    v_mfma_f32_32x32x16_bf16 v[144:159], v[48:51], a[148:151], v[144:159]
    ds_read_b64_tr_b16 v[48:49], v26 offset:14336
    ds_read_b64_tr_b16 v[50:51], v26 offset:14848
    s_waitcnt lgkmcnt(2)
    v_mfma_f32_32x32x16_bf16 v[128:143], v[40:43], a[24:27], v[128:143]
    v_mfma_f32_32x32x16_bf16 v[144:159], v[40:43], a[152:155], v[144:159]
    ds_read_b64_tr_b16 v[40:41], v26 offset:16384
    ds_read_b64_tr_b16 v[42:43], v26 offset:16896
    s_waitcnt lgkmcnt(2)
    v_mfma_f32_32x32x16_bf16 v[128:143], v[48:51], a[28:31], v[128:143]
    v_mfma_f32_32x32x16_bf16 v[144:159], v[48:51], a[156:159], v[144:159]
    ds_read_b64_tr_b16 v[48:49], v26 offset:18432
    ds_read_b64_tr_b16 v[50:51], v26 offset:18944
    s_waitcnt lgkmcnt(2)
    v_mfma_f32_32x32x16_bf16 v[128:143], v[40:43], a[32:35], v[128:143]
    v_mfma_f32_32x32x16_bf16 v[144:159], v[40:43], a[160:163], v[144:159]
    ds_read_b64_tr_b16 v[40:41], v26 offset:20480
    ds_read_b64_tr_b16 v[42:43], v26 offset:20992
    s_waitcnt lgkmcnt(2)
    v_mfma_f32_32x32x16_bf16 v[128:143], v[48:51], a[36:39], v[128:143]
    v_mfma_f32_32x32x16_bf16 v[144:159], v[48:51], a[164:167], v[144:159]
    ds_read_b64_tr_b16 v[48:49], v26 offset:22528
    ds_read_b64_tr_b16 v[50:51], v26 offset:23040
    s_waitcnt lgkmcnt(2)
    v_mfma_f32_32x32x16_bf16 v[128:143], v[40:43], a[40:43], v[128:143]
    v_mfma_f32_32x32x16_bf16 v[144:159], v[40:43], a[168:171], v[144:159]
    ds_read_b64_tr_b16 v[40:41], v26 offset:24576
    ds_read_b64_tr_b16 v[42:43], v26 offset:25088
    s_waitcnt lgkmcnt(2)
    v_mfma_f32_32x32x16_bf16 v[128:143], v[48:51], a[44:47], v[128:143]
    v_mfma_f32_32x32x16_bf16 v[144:159], v[48:51], a[172:175], v[144:159]
    ds_read_b64_tr_b16 v[48:49], v26 offset:26624
    ds_read_b64_tr_b16 v[50:51], v26 offset:27136
    s_waitcnt lgkmcnt(2)
    v_mfma_f32_32x32x16_bf16 v[128:143], v[40:43], a[48:51], v[128:143]
    v_mfma_f32_32x32x16_bf16 v[144:159], v[40:43], a[176:179], v[144:159]
    ds_read_b64_tr_b16 v[40:41], v26 offset:28672
    ds_read_b64_tr_b16 v[42:43], v26 offset:29184
    s_waitcnt lgkmcnt(2)
    v_mfma_f32_32x32x16_bf16 v[128:143], v[48:51], a[52:55], v[128:143]
    s_waitcnt vmcnt(38)
    ds_read_b64_tr_b16 a[0:1], v27 offset:0
    ds_read_b64_tr_b16 a[2:3], v27 offset:1024
    ds_read_b64_tr_b16 a[128:129], v28 offset:0
    ds_read_b64_tr_b16 a[130:131], v28 offset:1024
    v_mfma_f32_32x32x16_bf16 v[144:159], v[48:51], a[180:183], v[144:159]
    ds_read_b64_tr_b16 v[48:49], v26 offset:30720
    ds_read_b64_tr_b16 v[50:51], v26 offset:31232
    s_waitcnt lgkmcnt(6)
    v_mfma_f32_32x32x16_bf16 v[128:143], v[40:43], a[56:59], v[128:143]
    s_waitcnt vmcnt(34)
    ds_read_b64_tr_b16 a[4:5], v27 offset:2048
    ds_read_b64_tr_b16 a[6:7], v27 offset:3072
    ds_read_b64_tr_b16 a[132:133], v28 offset:2048
    ds_read_b64_tr_b16 a[134:135], v28 offset:3072
    v_mfma_f32_32x32x16_bf16 v[144:159], v[40:43], a[184:187], v[144:159]
    ds_read_b64_tr_b16 v[40:41], v26 offset:32768
    ds_read_b64_tr_b16 v[42:43], v26 offset:33280
    s_waitcnt lgkmcnt(6)
    v_mfma_f32_32x32x16_bf16 v[128:143], v[48:51], a[60:63], v[128:143]
    s_waitcnt vmcnt(30)
    ds_read_b64_tr_b16 a[8:9], v27 offset:4096
    ds_read_b64_tr_b16 a[10:11], v27 offset:5120
    ds_read_b64_tr_b16 a[136:137], v28 offset:4096
    ds_read_b64_tr_b16 a[138:139], v28 offset:5120
    v_mfma_f32_32x32x16_bf16 v[144:159], v[48:51], a[188:191], v[144:159]
    ds_read_b64_tr_b16 v[48:49], v26 offset:34816
    ds_read_b64_tr_b16 v[50:51], v26 offset:35328
    s_waitcnt lgkmcnt(6)
    v_mfma_f32_32x32x16_bf16 v[128:143], v[40:43], a[64:67], v[128:143]
    s_waitcnt vmcnt(25)
    ds_read_b64_tr_b16 a[12:13], v27 offset:6144
    ds_read_b64_tr_b16 a[14:15], v27 offset:7168
    ds_read_b64_tr_b16 a[140:141], v28 offset:6144
    ds_read_b64_tr_b16 a[142:143], v28 offset:7168
    v_mfma_f32_32x32x16_bf16 v[144:159], v[40:43], a[192:195], v[144:159]
    ds_read_b64_tr_b16 v[40:41], v26 offset:36864
    ds_read_b64_tr_b16 v[42:43], v26 offset:37376
    s_waitcnt lgkmcnt(6)
    v_mfma_f32_32x32x16_bf16 v[128:143], v[48:51], a[68:71], v[128:143]
    s_waitcnt vmcnt(21)
    ds_read_b64_tr_b16 a[16:17], v27 offset:8192
    ds_read_b64_tr_b16 a[18:19], v27 offset:9216
    ds_read_b64_tr_b16 a[144:145], v28 offset:8192
    ds_read_b64_tr_b16 a[146:147], v28 offset:9216
    v_mfma_f32_32x32x16_bf16 v[144:159], v[48:51], a[196:199], v[144:159]
    ds_read_b64_tr_b16 v[48:49], v26 offset:38912
    ds_read_b64_tr_b16 v[50:51], v26 offset:39424
    s_waitcnt lgkmcnt(6)
    v_mfma_f32_32x32x16_bf16 v[128:143], v[40:43], a[72:75], v[128:143]
    s_waitcnt vmcnt(19)
    ds_read_b64_tr_b16 a[20:21], v27 offset:10240
    ds_read_b64_tr_b16 a[22:23], v27 offset:11264
    ds_read_b64_tr_b16 a[148:149], v28 offset:10240
    ds_read_b64_tr_b16 a[150:151], v28 offset:11264
    v_mfma_f32_32x32x16_bf16 v[144:159], v[40:43], a[200:203], v[144:159]
    ds_read_b64_tr_b16 v[40:41], v26 offset:40960
    ds_read_b64_tr_b16 v[42:43], v26 offset:41472
    s_waitcnt lgkmcnt(6)
    v_mfma_f32_32x32x16_bf16 v[128:143], v[48:51], a[76:79], v[128:143]
    s_waitcnt vmcnt(17)
    ds_read_b64_tr_b16 a[24:25], v27 offset:12288
    ds_read_b64_tr_b16 a[26:27], v27 offset:13312
    ds_read_b64_tr_b16 a[152:153], v28 offset:12288
    ds_read_b64_tr_b16 a[154:155], v28 offset:13312
    v_mfma_f32_32x32x16_bf16 v[144:159], v[48:51], a[204:207], v[144:159]
    ds_read_b64_tr_b16 v[48:49], v26 offset:43008
    ds_read_b64_tr_b16 v[50:51], v26 offset:43520
    s_waitcnt lgkmcnt(6)
    v_mfma_f32_32x32x16_bf16 v[128:143], v[40:43], a[80:83], v[128:143]
    s_waitcnt vmcnt(15)
    ds_read_b64_tr_b16 a[28:29], v27 offset:14336
    ds_read_b64_tr_b16 a[30:31], v27 offset:15360
    ds_read_b64_tr_b16 a[156:157], v28 offset:14336
    ds_read_b64_tr_b16 a[158:159], v28 offset:15360
    v_mfma_f32_32x32x16_bf16 v[144:159], v[40:43], a[208:211], v[144:159]
    ds_read_b64_tr_b16 v[40:41], v26 offset:45056
    ds_read_b64_tr_b16 v[42:43], v26 offset:45568
    s_waitcnt lgkmcnt(6)
    v_mfma_f32_32x32x16_bf16 v[128:143], v[48:51], a[84:87], v[128:143]
    s_waitcnt vmcnt(4)
    s_lshr_b32 s68, s100, 8
    s_lshl_b32 s68, s68, 2
    s_and_b32 s69, s100, 255
    s_lshl_b32 s69, s69, 6
    s_add_u32 s68, s68, s69
    s_add_u32 s68, s68, 10510336
    v_mov_b32 v62, 0
    v_mov_b32 v63, s64
    s_mov_b64 exec, 1
    buffer_store_dword v63, v62, s[48:51], s68 offen sc1
    s_mov_b64 exec, -1
    s_waitcnt vmcnt(14)
    ds_read_b64_tr_b16 v[192:193], v27 offset:16384
    ds_read_b64_tr_b16 v[194:195], v27 offset:17408
    ds_read_b64_tr_b16 v[196:197], v28 offset:16384
    ds_read_b64_tr_b16 v[198:199], v28 offset:17408
    v_mfma_f32_32x32x16_bf16 v[144:159], v[48:51], a[212:215], v[144:159]
    ds_read_b64_tr_b16 v[48:49], v26 offset:47104
    ds_read_b64_tr_b16 v[50:51], v26 offset:47616
    s_waitcnt lgkmcnt(6)
    v_mfma_f32_32x32x16_bf16 v[128:143], v[40:43], a[88:91], v[128:143]
    s_waitcnt lgkmcnt(15)
    s_add_u32 m0, s76, 0
    s_add_u32 s81, s81, 16384
    s_and_b32 s81, s81, 262143
    buffer_load_dwordx4 v12, s[40:43], s81 offen lds
    buffer_load_dwordx4 v13, s[40:43], s81 offen offset:1024 lds
    s_waitcnt vmcnt(5)
    ds_read_b64_tr_b16 v[200:201], v27 offset:18432
    ds_read_b64_tr_b16 v[202:203], v27 offset:19456
    ds_read_b64_tr_b16 v[204:205], v28 offset:18432
    ds_read_b64_tr_b16 v[206:207], v28 offset:19456
    v_mfma_f32_32x32x16_bf16 v[144:159], v[40:43], a[216:219], v[144:159]
    ds_read_b64_tr_b16 v[40:41], v26 offset:49152
    ds_read_b64_tr_b16 v[42:43], v26 offset:49664
    s_waitcnt lgkmcnt(6)
    v_mfma_f32_32x32x16_bf16 v[128:143], v[48:51], a[92:95], v[128:143]
    s_waitcnt vmcnt(3)
    ds_read_b64_tr_b16 v[14:15], v27 offset:20480
    ds_read_b64_tr_b16 v[16:17], v27 offset:21504
    ds_read_b64_tr_b16 v[18:19], v28 offset:20480
    ds_read_b64_tr_b16 v[20:21], v28 offset:21504
    v_mfma_f32_32x32x16_bf16 v[144:159], v[48:51], a[220:223], v[144:159]
    ds_read_b64_tr_b16 v[48:49], v26 offset:51200
    ds_read_b64_tr_b16 v[50:51], v26 offset:51712
    s_waitcnt lgkmcnt(6)
    v_mfma_f32_32x32x16_bf16 v[128:143], v[40:43], a[96:99], v[128:143]
    s_waitcnt lgkmcnt(15)
    s_add_u32 m0, s76, 2048
    s_add_u32 s81, s81, 16384
    s_and_b32 s81, s81, 262143
    buffer_load_dwordx4 v12, s[40:43], s81 offen lds
    buffer_load_dwordx4 v13, s[40:43], s81 offen offset:1024 lds
    v_mfma_f32_32x32x16_bf16 v[144:159], v[40:43], a[224:227], v[144:159]
    ds_read_b64_tr_b16 v[40:41], v26 offset:53248
    ds_read_b64_tr_b16 v[42:43], v26 offset:53760
    s_waitcnt lgkmcnt(2)
    v_mfma_f32_32x32x16_bf16 v[128:143], v[48:51], a[100:103], v[128:143]
    v_mfma_f32_32x32x16_bf16 v[144:159], v[48:51], a[228:231], v[144:159]
    ds_read_b64_tr_b16 v[48:49], v26 offset:55296
    ds_read_b64_tr_b16 v[50:51], v26 offset:55808
    s_waitcnt lgkmcnt(2)
    v_mfma_f32_32x32x16_bf16 v[128:143], v[40:43], a[104:107], v[128:143]
    s_waitcnt lgkmcnt(15)
    s_add_u32 m0, s76, 4096
    s_add_u32 s81, s81, 16384
    s_and_b32 s81, s81, 262143
    buffer_load_dwordx4 v12, s[40:43], s81 offen lds
    buffer_load_dwordx4 v13, s[40:43], s81 offen offset:1024 lds
    v_mfma_f32_32x32x16_bf16 v[144:159], v[40:43], a[232:235], v[144:159]
    ds_read_b64_tr_b16 v[40:41], v26 offset:57344
    ds_read_b64_tr_b16 v[42:43], v26 offset:57856
    s_waitcnt lgkmcnt(2)
    v_mfma_f32_32x32x16_bf16 v[128:143], v[48:51], a[108:111], v[128:143]
    v_mfma_f32_32x32x16_bf16 v[144:159], v[48:51], a[236:239], v[144:159]
    ds_read_b64_tr_b16 v[48:49], v26 offset:59392
    ds_read_b64_tr_b16 v[50:51], v26 offset:59904
    s_waitcnt lgkmcnt(2)
    v_mfma_f32_32x32x16_bf16 v[128:143], v[40:43], a[112:115], v[128:143]
    s_waitcnt lgkmcnt(15)
    s_add_u32 m0, s76, 6144
    s_add_u32 s81, s81, 16384
    s_and_b32 s81, s81, 262143
    buffer_load_dwordx4 v12, s[40:43], s81 offen lds
    buffer_load_dwordx4 v13, s[40:43], s81 offen offset:1024 lds
    v_mfma_f32_32x32x16_bf16 v[144:159], v[40:43], a[240:243], v[144:159]
    ds_read_b64_tr_b16 v[40:41], v26 offset:61440
    ds_read_b64_tr_b16 v[42:43], v26 offset:61952
    s_waitcnt lgkmcnt(2)
    v_mfma_f32_32x32x16_bf16 v[128:143], v[48:51], a[116:119], v[128:143]
    v_mfma_f32_32x32x16_bf16 v[144:159], v[48:51], a[244:247], v[144:159]
    ds_read_b64_tr_b16 v[48:49], v26 offset:63488
    ds_read_b64_tr_b16 v[50:51], v26 offset:64000
    s_waitcnt lgkmcnt(2)
    v_mfma_f32_32x32x16_bf16 v[128:143], v[40:43], a[120:123], v[128:143]
    v_mfma_f32_32x32x16_bf16 v[144:159], v[40:43], a[248:251], v[144:159]
    s_waitcnt lgkmcnt(0)
    s_barrier
    v_mfma_f32_32x32x16_bf16 v[128:143], v[48:51], a[124:127], v[128:143]
    v_mfma_f32_32x32x16_bf16 v[144:159], v[48:51], a[252:255], v[144:159]
    v_and_b32 v35, 15, v1
    v_lshlrev_b32 v35, 2, v35
    s_mul_i32 s68, s61, s84
    s_cmp_lg_u32 s68, 0
    s_cselect_b32 s69, 1, 0
    s_add_u32 s69, s69, s83
    s_lshl_b32 s69, s69, 11
    s_cmp_gt_u32 s61, s84
    s_cbranch_scc1 LKV_gate12
    s_nop 1
    v_cvt_pk_bf16_f32 v128, v128, v129
    v_cvt_pk_bf16_f32 v129, v130, v131
    v_cvt_pk_bf16_f32 v130, v132, v133
    v_cvt_pk_bf16_f32 v131, v134, v135
    v_cvt_pk_bf16_f32 v132, v136, v137
    v_cvt_pk_bf16_f32 v133, v138, v139
    v_cvt_pk_bf16_f32 v134, v140, v141
    v_cvt_pk_bf16_f32 v135, v142, v143
    v_pk_max_i16 v128, v128, 0
    v_pk_max_i16 v129, v129, 0
    v_pk_max_i16 v130, v130, 0
    v_pk_max_i16 v131, v131, 0
    v_pk_max_i16 v132, v132, 0
    v_pk_max_i16 v133, v133, 0
    v_pk_max_i16 v134, v134, 0
    v_pk_max_i16 v135, v135, 0
    buffer_store_dwordx4 v[128:131], v33, s[48:51], s69 offen sc1
    buffer_store_dwordx4 v[132:135], v33, s[48:51], s69 offen offset:1024 sc1
    v_cvt_pk_bf16_f32 v144, v144, v145
    v_cvt_pk_bf16_f32 v145, v146, v147
    v_cvt_pk_bf16_f32 v146, v148, v149
    v_cvt_pk_bf16_f32 v147, v150, v151
    v_cvt_pk_bf16_f32 v148, v152, v153
    v_cvt_pk_bf16_f32 v149, v154, v155
    v_cvt_pk_bf16_f32 v150, v156, v157
    v_cvt_pk_bf16_f32 v151, v158, v159
    v_pk_max_i16 v144, v144, 0
    v_pk_max_i16 v145, v145, 0
    v_pk_max_i16 v146, v146, 0
    v_pk_max_i16 v147, v147, 0
    v_pk_max_i16 v148, v148, 0
    v_pk_max_i16 v149, v149, 0
    v_pk_max_i16 v150, v150, 0
    v_pk_max_i16 v151, v151, 0
    buffer_store_dwordx4 v[144:147], v34, s[48:51], s69 offen sc1
    buffer_store_dwordx4 v[148:151], v34, s[48:51], s69 offen offset:1024 sc1
    s_branch LKV_hdone13
LKV_gate12:
    s_cmp_lg_u32 s58, 6
    s_cbranch_scc1 LKV_hdone13
    v_mul_f32_e64 v56, -v128, s98
    v_exp_f32 v56, v56
    s_nop 0
    v_add_f32 v56, 1.0, v56
    v_rcp_f32 v56, v56
    v_mul_f32_e64 v57, -v144, s98
    v_exp_f32 v57, v57
    s_nop 0
    v_add_f32 v57, 1.0, v57
    v_rcp_f32 v57, v57
    s_and_b32 s68, s100, 0xff00
    s_add_u32 s68, s68, 9437184
    v_lshlrev_b32 v58, 2, v1
    s_mov_b32 exec_hi, 0
    buffer_store_dword v56, v58, s[48:51], s68 offen sc1
    buffer_store_dword v57, v58, s[48:51], s68 offen offset:128 sc1
    s_mov_b32 exec_hi, -1
LKV_hdone13:
    buffer_load_dword v36, v35, s[48:51], s101 offen offset:0 sc1
    s_waitcnt lgkmcnt(15)
    s_add_u32 m0, s76, 8192
    s_add_u32 s81, s81, 16384
    s_and_b32 s81, s81, 262143
    buffer_load_dwordx4 v12, s[40:43], s81 offen lds
    buffer_load_dwordx4 v13, s[40:43], s81 offen offset:1024 lds
    s_waitcnt lgkmcnt(15)
    s_add_u32 m0, s76, 10240
    s_lshl_b32 s71, s56, 4
    s_sub_u32 s71, s78, s71
    s_lshl_b32 s71, s71, 14
    v_add_u32 v12, s71, v12
    v_add_u32 v13, s71, v13
    s_lshr_b32 s81, s65, 2
    s_lshl_b32 s81, s81, 14
    buffer_load_dwordx4 v12, s[40:43], s81 offen lds
    buffer_load_dwordx4 v13, s[40:43], s81 offen offset:1024 lds
    s_waitcnt lgkmcnt(15)
    s_add_u32 m0, s76, 12288
    s_add_u32 s81, s81, 16384
    s_cmp_eq_u32 s81, s79
    s_cselect_b32 s81, 0, s81
    buffer_load_dwordx4 v12, s[40:43], s81 offen lds
    buffer_load_dwordx4 v13, s[40:43], s81 offen offset:1024 lds
    s_waitcnt lgkmcnt(15)
    s_add_u32 m0, s76, 14336
    s_add_u32 s81, s81, 16384
    s_cmp_eq_u32 s81, s79
    s_cselect_b32 s81, 0, s81
    buffer_load_dwordx4 v12, s[40:43], s81 offen lds
    buffer_load_dwordx4 v13, s[40:43], s81 offen offset:1024 lds
    s_add_u32 s69, s100, 10493952
    s_waitcnt vmcnt(8)
    v_mov_b32 v62, 0
    v_mov_b32 v63, s64
    s_mov_b64 exec, 1
    buffer_store_dword v63, v62, s[48:51], s69 offen sc1
    s_mov_b64 exec, -1
    s_waitcnt vmcnt(9)
    v_cmp_ne_u32 vcc, s64, v36
    s_nop 1
    s_cbranch_vccnz LKV_pdone15_ool3
LKV_pdone15:
    buffer_load_dwordx4 a[56:59], v31, s[48:51], s82 offen sc1
    buffer_load_dwordx4 a[184:187], v32, s[48:51], s82 offen sc1
    s_add_u32 s82, s82, 1024
    s_and_b32 s82, s82, 16383
    buffer_load_dwordx4 a[60:63], v31, s[48:51], s82 offen sc1
    buffer_load_dwordx4 a[188:191], v32, s[48:51], s82 offen sc1
    s_add_u32 s82, s82, 1024
    s_and_b32 s82, s82, 16383
    buffer_load_dwordx4 a[64:67], v31, s[48:51], s82 offen sc1
    buffer_load_dwordx4 a[192:195], v32, s[48:51], s82 offen sc1
    s_add_u32 s82, s82, 1024
    s_and_b32 s82, s82, 16383
    buffer_load_dwordx4 a[68:71], v31, s[48:51], s82 offen sc1
    buffer_load_dwordx4 a[196:199], v32, s[48:51], s82 offen sc1
    s_add_u32 s82, s82, 1024
    s_and_b32 s82, s82, 16383
    buffer_load_dwordx4 a[72:75], v31, s[48:51], s82 offen sc1
    buffer_load_dwordx4 a[200:203], v32, s[48:51], s82 offen sc1
    s_add_u32 s82, s82, 1024
    s_and_b32 s82, s82, 16383
    buffer_load_dwordx4 a[76:79], v31, s[48:51], s82 offen sc1
    buffer_load_dwordx4 a[204:207], v32, s[48:51], s82 offen sc1
    s_add_u32 s82, s82, 1024
    s_and_b32 s82, s82, 16383
    s_waitcnt lgkmcnt(15)
    s_waitcnt vmcnt(10)
    v_mfma_f32_32x32x16_bf16 v[64:79], a[0:3], a[56:59], 0
    buffer_load_dwordx4 a[80:83], v31, s[48:51], s82 offen sc1
    buffer_load_dwordx4 a[208:211], v32, s[48:51], s82 offen sc1
    v_mfma_f32_32x32x16_bf16 v[80:95], a[0:3], a[184:187], 0
    s_add_u32 s82, s82, 1024
    s_and_b32 s82, s82, 16383
    s_waitcnt lgkmcnt(15)
    s_add_u32 m0, s76, 16384
    s_add_u32 s81, s81, 16384
    s_cmp_eq_u32 s81, s79
    s_cselect_b32 s81, 0, s81
    buffer_load_dwordx4 v12, s[40:43], s81 offen lds
    v_mfma_f32_32x32x16_bf16 v[96:111], a[128:131], a[56:59], 0
    buffer_load_dwordx4 v13, s[40:43], s81 offen offset:1024 lds
    s_waitcnt lgkmcnt(15)
    s_add_u32 m0, s76, 18432
    s_add_u32 s81, s81, 16384
    s_cmp_eq_u32 s81, s79
    s_cselect_b32 s81, 0, s81
    buffer_load_dwordx4 v12, s[40:43], s81 offen lds
    v_mfma_f32_32x32x16_bf16 v[112:127], a[128:131], a[184:187], 0
    buffer_load_dwordx4 v13, s[40:43], s81 offen offset:1024 lds
    s_waitcnt lgkmcnt(15)
    s_waitcnt vmcnt(14)
    v_mfma_f32_32x32x16_bf16 v[64:79], a[4:7], a[60:63], v[64:79]
    v_mfma_f32_32x32x16_bf16 v[80:95], a[4:7], a[188:191], v[80:95]
    buffer_load_dwordx4 a[84:87], v31, s[48:51], s82 offen sc1
    buffer_load_dwordx4 a[212:215], v32, s[48:51], s82 offen sc1
    s_add_u32 s82, s82, 1024
    s_and_b32 s82, s82, 16383
    s_waitcnt lgkmcnt(14)
    s_add_u32 m0, s76, 20480
    s_add_u32 s81, s81, 16384
    s_cmp_eq_u32 s81, s79
    s_cselect_b32 s81, 0, s81
    s_cmp_ge_u32 s56, 2
    s_cbranch_scc1 LKV_skip17
    buffer_load_dwordx4 v12, s[40:43], s81 offen lds
    buffer_load_dwordx4 v13, s[40:43], s81 offen offset:1024 lds
LKV_skip17:
    s_add_u32 m0, s77, 0
    s_lshl_b32 s71, s56, 3
    s_sub_u32 s71, s71, s78
    s_lshl_b32 s71, s71, 14
    v_add_u32 v12, s71, v12
    v_add_u32 v13, s71, v13
    s_lshr_b32 s81, s65, 1
    s_lshl_b32 s81, s81, 14
    buffer_load_dwordx4 v12, s[44:47], s81 offen lds
    buffer_load_dwordx4 v13, s[44:47], s81 offen offset:1024 lds
    v_mfma_f32_32x32x16_bf16 v[96:111], a[132:135], a[60:63], v[96:111]
    v_mfma_f32_32x32x16_bf16 v[112:127], a[132:135], a[188:191], v[112:127]
    s_waitcnt lgkmcnt(15)
    s_waitcnt vmcnt(16)
    v_mfma_f32_32x32x16_bf16 v[64:79], a[8:11], a[64:67], v[64:79]
    buffer_load_dwordx4 a[88:91], v31, s[48:51], s82 offen sc1
    buffer_load_dwordx4 a[216:219], v32, s[48:51], s82 offen sc1
    v_mfma_f32_32x32x16_bf16 v[80:95], a[8:11], a[192:195], v[80:95]
    s_add_u32 s82, s82, 1024
    s_and_b32 s82, s82, 16383
    s_add_u32 m0, s77, 2048
    s_add_u32 s81, s81, 16384
    s_and_b32 s81, s81, 131071
    buffer_load_dwordx4 v12, s[44:47], s81 offen lds
    v_mfma_f32_32x32x16_bf16 v[96:111], a[136:139], a[64:67], v[96:111]
    buffer_load_dwordx4 v13, s[44:47], s81 offen offset:1024 lds
    s_add_u32 m0, s77, 4096
    s_add_u32 s81, s81, 16384
    s_and_b32 s81, s81, 131071
    buffer_load_dwordx4 v12, s[44:47], s81 offen lds
    v_mfma_f32_32x32x16_bf16 v[112:127], a[136:139], a[192:195], v[112:127]
    buffer_load_dwordx4 v13, s[44:47], s81 offen offset:1024 lds
    s_waitcnt lgkmcnt(15)
    s_waitcnt vmcnt(20)
    v_mfma_f32_32x32x16_bf16 v[64:79], a[12:15], a[68:71], v[64:79]
    buffer_load_dwordx4 a[92:95], v31, s[48:51], s82 offen sc1
    buffer_load_dwordx4 a[220:223], v32, s[48:51], s82 offen sc1
    v_mfma_f32_32x32x16_bf16 v[80:95], a[12:15], a[196:199], v[80:95]
    s_add_u32 s82, s82, 1024
    s_and_b32 s82, s82, 16383
    s_add_u32 m0, s77, 6144
    s_add_u32 s81, s81, 16384
    s_and_b32 s81, s81, 131071
    buffer_load_dwordx4 v12, s[44:47], s81 offen lds
    v_mfma_f32_32x32x16_bf16 v[96:111], a[140:143], a[68:71], v[96:111]
    buffer_load_dwordx4 v13, s[44:47], s81 offen offset:1024 lds
    s_add_u32 m0, s77, 8192
    s_add_u32 s81, s81, 16384
    s_and_b32 s81, s81, 131071
    buffer_load_dwordx4 v12, s[44:47], s81 offen lds
    v_mfma_f32_32x32x16_bf16 v[112:127], a[140:143], a[196:199], v[112:127]
    buffer_load_dwordx4 v13, s[44:47], s81 offen offset:1024 lds
    s_waitcnt lgkmcnt(15)
    s_waitcnt vmcnt(24)
    v_mfma_f32_32x32x16_bf16 v[64:79], a[16:19], a[72:75], v[64:79]
    buffer_load_dwordx4 a[96:99], v31, s[48:51], s82 offen sc1
    buffer_load_dwordx4 a[224:227], v32, s[48:51], s82 offen sc1
    v_mfma_f32_32x32x16_bf16 v[80:95], a[16:19], a[200:203], v[80:95]
    s_add_u32 s82, s82, 1024
    s_and_b32 s82, s82, 16383
    s_add_u32 m0, s77, 10240
    s_add_u32 s81, s81, 16384
    s_and_b32 s81, s81, 131071
    buffer_load_dwordx4 v12, s[44:47], s81 offen lds
    v_mfma_f32_32x32x16_bf16 v[96:111], a[144:147], a[72:75], v[96:111]
    buffer_load_dwordx4 v13, s[44:47], s81 offen offset:1024 lds
    s_add_u32 m0, s77, 12288
    s_add_u32 s81, s81, 16384
    s_and_b32 s81, s81, 131071
    buffer_load_dwordx4 v12, s[44:47], s81 offen lds
    v_mfma_f32_32x32x16_bf16 v[112:127], a[144:147], a[200:203], v[112:127]
    buffer_load_dwordx4 v13, s[44:47], s81 offen offset:1024 lds
    s_waitcnt lgkmcnt(15)
    s_waitcnt vmcnt(28)
    v_mfma_f32_32x32x16_bf16 v[64:79], a[20:23], a[76:79], v[64:79]
    buffer_load_dwordx4 a[100:103], v31, s[48:51], s82 offen sc1
    v_mfma_f32_32x32x16_bf16 v[80:95], a[20:23], a[204:207], v[80:95]
    buffer_load_dwordx4 a[228:231], v32, s[48:51], s82 offen sc1
    v_mfma_f32_32x32x16_bf16 v[96:111], a[148:151], a[76:79], v[96:111]
    s_add_u32 s82, s82, 1024
    s_and_b32 s82, s82, 16383
    s_add_u32 m0, s77, 14336
    s_add_u32 s81, s81, 16384
    s_and_b32 s81, s81, 131071
    buffer_load_dwordx4 v12, s[44:47], s81 offen lds
    v_mfma_f32_32x32x16_bf16 v[112:127], a[148:151], a[204:207], v[112:127]
    buffer_load_dwordx4 v13, s[44:47], s81 offen offset:1024 lds
    s_waitcnt lgkmcnt(15)
    s_waitcnt vmcnt(30)
    v_mfma_f32_32x32x16_bf16 v[64:79], a[24:27], a[80:83], v[64:79]
    buffer_load_dwordx4 a[104:107], v31, s[48:51], s82 offen sc1
    v_mfma_f32_32x32x16_bf16 v[80:95], a[24:27], a[208:211], v[80:95]
    buffer_load_dwordx4 a[232:235], v32, s[48:51], s82 offen sc1
    v_mfma_f32_32x32x16_bf16 v[96:111], a[152:155], a[80:83], v[96:111]
    s_add_u32 s82, s82, 1024
    s_and_b32 s82, s82, 16383
    v_mfma_f32_32x32x16_bf16 v[112:127], a[152:155], a[208:211], v[112:127]
    s_waitcnt lgkmcnt(15)
    s_waitcnt vmcnt(26)
    v_mfma_f32_32x32x16_bf16 v[64:79], a[28:31], a[84:87], v[64:79]
    buffer_load_dwordx4 a[108:111], v31, s[48:51], s82 offen sc1
    v_mfma_f32_32x32x16_bf16 v[80:95], a[28:31], a[212:215], v[80:95]
    buffer_load_dwordx4 a[236:239], v32, s[48:51], s82 offen sc1
    v_mfma_f32_32x32x16_bf16 v[96:111], a[156:159], a[84:87], v[96:111]
    s_add_u32 s82, s82, 1024
    s_and_b32 s82, s82, 16383
    v_mfma_f32_32x32x16_bf16 v[112:127], a[156:159], a[212:215], v[112:127]
    s_waitcnt lgkmcnt(15)
    s_waitcnt vmcnt(24)
    v_mfma_f32_32x32x16_bf16 v[64:79], v[192:195], a[88:91], v[64:79]
    buffer_load_dwordx4 a[112:115], v31, s[48:51], s82 offen sc1
    v_mfma_f32_32x32x16_bf16 v[80:95], v[192:195], a[216:219], v[80:95]
    buffer_load_dwordx4 a[240:243], v32, s[48:51], s82 offen sc1
    v_mfma_f32_32x32x16_bf16 v[96:111], v[196:199], a[88:91], v[96:111]
    s_add_u32 s82, s82, 1024
    s_and_b32 s82, s82, 16383
    v_mfma_f32_32x32x16_bf16 v[112:127], v[196:199], a[216:219], v[112:127]
    s_waitcnt lgkmcnt(15)
    s_waitcnt vmcnt(20)
    v_mfma_f32_32x32x16_bf16 v[64:79], v[200:203], a[92:95], v[64:79]
    buffer_load_dwordx4 a[116:119], v31, s[48:51], s82 offen sc1
    v_mfma_f32_32x32x16_bf16 v[80:95], v[200:203], a[220:223], v[80:95]
    buffer_load_dwordx4 a[244:247], v32, s[48:51], s82 offen sc1
    v_mfma_f32_32x32x16_bf16 v[96:111], v[204:207], a[92:95], v[96:111]
    s_add_u32 s27, s101, 8192
    buffer_load_dword v36, v35, s[48:51], s27 offen sc1
    v_mfma_f32_32x32x16_bf16 v[112:127], v[204:207], a[220:223], v[112:127]
    s_waitcnt lgkmcnt(14)
    s_waitcnt vmcnt(17)
    s_waitcnt vmcnt(63)
    v_mfma_f32_32x32x16_bf16 v[64:79], v[14:17], a[96:99], v[64:79]
    ds_read_b64_tr_b16 v[48:49], v27 offset:0
    v_mfma_f32_32x32x16_bf16 v[80:95], v[14:17], a[224:227], v[80:95]
    ds_read_b64_tr_b16 v[50:51], v27 offset:1024
    v_mfma_f32_32x32x16_bf16 v[96:111], v[18:21], a[96:99], v[96:111]
    ds_read_b64_tr_b16 v[52:53], v28 offset:0
    v_mfma_f32_32x32x16_bf16 v[112:127], v[18:21], a[224:227], v[112:127]
    ds_read_b64_tr_b16 v[54:55], v28 offset:1024
    s_lshl_b32 s68, s61, 1
    s_sub_u32 s68, 1, s68
    s_lshl_b32 s68, s68, 14
    v_add_u32 v2, s68, v29
    v_add_u32 v3, s68, v30
    s_waitcnt vmcnt(9)
    s_barrier
    s_waitcnt lgkmcnt(0)
    s_waitcnt vmcnt(11)
    s_waitcnt vmcnt(63)
    v_mfma_f32_32x32x16_bf16 v[64:79], v[48:51], a[100:103], v[64:79]
    ds_read_b64_tr_b16 v[40:41], v27 offset:2048
    ds_read_b64_tr_b16 v[42:43], v27 offset:3072
    ds_read_b64_tr_b16 v[44:45], v28 offset:2048
    v_mfma_f32_32x32x16_bf16 v[80:95], v[48:51], a[228:231], v[80:95]
    ds_read_b64_tr_b16 v[46:47], v28 offset:3072
    ds_read_b64_tr_b16 v[128:129], v29 offset:0
    ds_read_b64_tr_b16 v[130:131], v29 offset:1024
    s_waitcnt vmcnt(0)
    v_cmp_ne_u32 vcc, s64, v36
    s_nop 1
    s_cbranch_vccnz LKV_pdone19_ool4
LKV_pdone19:
    s_lshl_b32 s71, s56, 4
    s_sub_u32 s71, s78, s71
    s_lshl_b32 s71, s71, 10
    v_add_u32 v31, s71, v31
    v_add_u32 v32, s71, v32
    s_lshr_b32 s82, s65, 2
    s_lshl_b32 s82, s82, 10
    buffer_load_dwordx4 a[32:35], v31, s[48:51], s82 offen sc1
    buffer_load_dwordx4 a[160:163], v32, s[48:51], s82 offen sc1
    s_add_u32 s82, s82, 1024
    s_cmp_eq_u32 s82, s80
    s_cselect_b32 s82, 0, s82
    s_lshl_b32 s68, s62, 8
    s_lshl_b32 s69, s61, 7
    s_add_u32 s68, s68, 9437184
    s_add_u32 s69, s69, s68
    s_xor_b32 s70, s69, 128
    v_and_b32 v56, 31, v1
    v_lshlrev_b32 v56, 2, v56
    buffer_load_dword v38, v56, s[48:51], s69 offen sc1
    buffer_load_dword v39, v56, s[48:51], s70 offen sc1
    v_mfma_f32_32x32x16_bf16 v[96:111], v[52:55], a[100:103], v[96:111]
    ds_read_b64_tr_b16 v[132:133], v30 offset:0
    ds_read_b64_tr_b16 v[134:135], v30 offset:1024
    ds_read_b64_tr_b16 v[136:137], v29 offset:2048
    v_mfma_f32_32x32x16_bf16 v[112:127], v[52:55], a[228:231], v[112:127]
    ds_read_b64_tr_b16 v[138:139], v29 offset:3072
    ds_read_b64_tr_b16 v[140:141], v30 offset:2048
    s_waitcnt lgkmcnt(7)
    s_waitcnt vmcnt(11)
    s_waitcnt vmcnt(63)
    v_mfma_f32_32x32x16_bf16 v[64:79], v[40:43], a[104:107], v[64:79]
    ds_read_b64_tr_b16 v[48:49], v27 offset:4096
    ds_read_b64_tr_b16 v[50:51], v27 offset:5120
    ds_read_b64_tr_b16 v[52:53], v28 offset:4096
    buffer_load_dwordx4 a[36:39], v31, s[48:51], s82 offen sc1
    v_mfma_f32_32x32x16_bf16 v[80:95], v[40:43], a[232:235], v[80:95]
    ds_read_b64_tr_b16 v[54:55], v28 offset:5120
    ds_read_b64_tr_b16 v[142:143], v30 offset:3072
    ds_read_b64_tr_b16 v[144:145], v29 offset:4096
    buffer_load_dwordx4 a[164:167], v32, s[48:51], s82 offen sc1
    v_mfma_f32_32x32x16_bf16 v[96:111], v[44:47], a[104:107], v[96:111]
    ds_read_b64_tr_b16 v[146:147], v29 offset:5120
    ds_read_b64_tr_b16 v[148:149], v30 offset:4096
    ds_read_b64_tr_b16 v[150:151], v30 offset:5120
    s_add_u32 s82, s82, 1024
    s_cmp_eq_u32 s82, s80
    s_cselect_b32 s82, 0, s82
    v_mfma_f32_32x32x16_bf16 v[112:127], v[44:47], a[232:235], v[112:127]
    ds_read_b64_tr_b16 v[152:153], v29 offset:6144
    ds_read_b64_tr_b16 v[154:155], v29 offset:7168
    s_waitcnt lgkmcnt(7)
    s_waitcnt vmcnt(11)
    s_waitcnt vmcnt(63)
    v_mfma_f32_32x32x16_bf16 v[64:79], v[48:51], a[108:111], v[64:79]
    ds_read_b64_tr_b16 v[40:41], v27 offset:6144
    ds_read_b64_tr_b16 v[42:43], v27 offset:7168
    ds_read_b64_tr_b16 v[44:45], v28 offset:6144
    buffer_load_dwordx4 a[40:43], v31, s[48:51], s82 offen sc1
    v_mfma_f32_32x32x16_bf16 v[80:95], v[48:51], a[236:239], v[80:95]
    ds_read_b64_tr_b16 v[46:47], v28 offset:7168
    ds_read_b64_tr_b16 v[156:157], v30 offset:6144
    ds_read_b64_tr_b16 v[158:159], v30 offset:7168
    buffer_load_dwordx4 a[168:171], v32, s[48:51], s82 offen sc1
    v_mfma_f32_32x32x16_bf16 v[96:111], v[52:55], a[108:111], v[96:111]
    ds_read_b64_tr_b16 v[192:193], v29 offset:8192
    ds_read_b64_tr_b16 v[194:195], v29 offset:9216
    ds_read_b64_tr_b16 v[196:197], v30 offset:8192
    s_add_u32 s82, s82, 1024
    s_cmp_eq_u32 s82, s80
    s_cselect_b32 s82, 0, s82
    v_mfma_f32_32x32x16_bf16 v[112:127], v[52:55], a[236:239], v[112:127]
    ds_read_b64_tr_b16 v[198:199], v30 offset:9216
    ds_read_b64_tr_b16 v[200:201], v29 offset:10240
    s_waitcnt lgkmcnt(7)
    s_waitcnt vmcnt(11)
    s_waitcnt vmcnt(63)
    v_mfma_f32_32x32x16_bf16 v[64:79], v[40:43], a[112:115], v[64:79]
    ds_read_b64_tr_b16 v[48:49], v27 offset:8192
    ds_read_b64_tr_b16 v[50:51], v27 offset:9216
    ds_read_b64_tr_b16 v[52:53], v28 offset:8192
    buffer_load_dwordx4 a[44:47], v31, s[48:51], s82 offen sc1
    v_mfma_f32_32x32x16_bf16 v[80:95], v[40:43], a[240:243], v[80:95]
    ds_read_b64_tr_b16 v[54:55], v28 offset:9216
    ds_read_b64_tr_b16 v[202:203], v29 offset:11264
    ds_read_b64_tr_b16 v[204:205], v30 offset:10240
    buffer_load_dwordx4 a[172:175], v32, s[48:51], s82 offen sc1
    v_mfma_f32_32x32x16_bf16 v[96:111], v[44:47], a[112:115], v[96:111]
    ds_read_b64_tr_b16 v[206:207], v30 offset:11264
    ds_read_b64_tr_b16 v[208:209], v29 offset:12288
    ds_read_b64_tr_b16 v[210:211], v29 offset:13312
    s_add_u32 s82, s82, 1024
    s_cmp_eq_u32 s82, s80
    s_cselect_b32 s82, 0, s82
    v_mfma_f32_32x32x16_bf16 v[112:127], v[44:47], a[240:243], v[112:127]
    ds_read_b64_tr_b16 v[212:213], v30 offset:12288
    ds_read_b64_tr_b16 v[214:215], v30 offset:13312
    s_waitcnt lgkmcnt(7)
    s_waitcnt vmcnt(11)
    v_mfma_f32_32x32x16_bf16 v[64:79], v[48:51], a[116:119], v[64:79]
    ds_read_b64_tr_b16 v[216:217], v29 offset:14336
    ds_read_b64_tr_b16 v[218:219], v29 offset:15360
    v_mfma_f32_32x32x16_bf16 v[80:95], v[48:51], a[244:247], v[80:95]
    ds_read_b64_tr_b16 v[220:221], v30 offset:14336
    ds_read_b64_tr_b16 v[222:223], v30 offset:15360
    buffer_load_dwordx4 a[48:51], v31, s[48:51], s82 offen sc1
    buffer_load_dwordx4 a[176:179], v32, s[48:51], s82 offen sc1
    s_add_u32 s82, s82, 1024
    s_cmp_eq_u32 s82, s80
    s_cselect_b32 s82, 0, s82
    s_cmp_ge_u32 s56, 2
    s_cbranch_scc1 LKV_skip21
    buffer_load_dwordx4 a[52:55], v31, s[48:51], s82 offen sc1
    buffer_load_dwordx4 a[180:183], v32, s[48:51], s82 offen sc1
LKV_skip21:
    s_add_u32 s27, s101, 16384
    buffer_load_dword v36, v35, s[48:51], s27 offen sc1
    v_mfma_f32_32x32x16_bf16 v[96:111], v[52:55], a[116:119], v[96:111]
    ds_read_b64_tr_b16 v[224:225], v2 offset:0
    ds_read_b64_tr_b16 v[226:227], v2 offset:1024
    v_mfma_f32_32x32x16_bf16 v[112:127], v[52:55], a[244:247], v[112:127]
    ds_read_b64_tr_b16 v[228:229], v3 offset:0
    s_waitcnt vmcnt(63)
    ds_read_b64_tr_b16 v[40:41], v27 offset:10240
    ds_read_b64_tr_b16 v[42:43], v27 offset:11264
    ds_read_b64_tr_b16 v[44:45], v28 offset:10240
    ds_read_b64_tr_b16 v[46:47], v28 offset:11264
    s_waitcnt lgkmcnt(0)
    s_waitcnt vmcnt(11)
    s_waitcnt vmcnt(63)
    v_mfma_f32_32x32x16_bf16 v[64:79], v[40:43], a[32:35], v[64:79]
    ds_read_b64_tr_b16 v[48:49], v27 offset:12288
    ds_read_b64_tr_b16 v[50:51], v27 offset:13312
    ds_read_b64_tr_b16 v[52:53], v28 offset:12288
    v_mfma_f32_32x32x16_bf16 v[80:95], v[40:43], a[160:163], v[80:95]
    ds_read_b64_tr_b16 v[54:55], v28 offset:13312
    ds_read_b64_tr_b16 v[230:231], v3 offset:1024
    ds_read_b64_tr_b16 v[232:233], v2 offset:2048
    v_mfma_f32_32x32x16_bf16 v[96:111], v[44:47], a[32:35], v[96:111]
    ds_read_b64_tr_b16 v[234:235], v2 offset:3072
    ds_read_b64_tr_b16 v[236:237], v3 offset:2048
    ds_read_b64_tr_b16 v[238:239], v3 offset:3072
    v_mfma_f32_32x32x16_bf16 v[112:127], v[44:47], a[160:163], v[112:127]
    ds_read_b64_tr_b16 v[240:241], v2 offset:4096
    ds_read_b64_tr_b16 v[242:243], v2 offset:5120
    s_waitcnt lgkmcnt(7)
    s_waitcnt vmcnt(7)
    s_waitcnt vmcnt(63)
    v_mfma_f32_32x32x16_bf16 v[64:79], v[48:51], a[36:39], v[64:79]
    ds_read_b64_tr_b16 v[40:41], v27 offset:14336
    ds_read_b64_tr_b16 v[42:43], v27 offset:15360
    ds_read_b64_tr_b16 v[44:45], v28 offset:14336
    v_mfma_f32_32x32x16_bf16 v[80:95], v[48:51], a[164:167], v[80:95]
    ds_read_b64_tr_b16 v[46:47], v28 offset:15360
    ds_read_b64_tr_b16 v[244:245], v3 offset:4096
    ds_read_b64_tr_b16 v[246:247], v3 offset:5120
    v_mfma_f32_32x32x16_bf16 v[96:111], v[52:55], a[36:39], v[96:111]
    ds_read_b64_tr_b16 v[248:249], v2 offset:6144
    ds_read_b64_tr_b16 v[250:251], v2 offset:7168
    ds_read_b64_tr_b16 v[252:253], v3 offset:6144
    v_mfma_f32_32x32x16_bf16 v[112:127], v[52:55], a[164:167], v[112:127]
    ds_read_b64_tr_b16 v[254:255], v3 offset:7168
    ds_read_b64_tr_b16 a[56:57], v2 offset:8192
    s_lshl_b32 s71, s56, 3
    s_add_u32 s71, s71, 86
    s_sub_u32 s71, s71, s78
    s_lshl_b32 s71, s71, 10
    v_add_u32 v31, s71, v31
    s_lshl_b32 s68, s61, 1
    s_sub_u32 s68, 1, s68
    s_lshl_b32 s69, s68, 13
    v_add_u32 v32, s69, v31
    s_lshr_b32 s82, s65, 1
    s_lshl_b32 s82, s82, 10
    s_waitcnt vmcnt(0)
    v_cmp_ne_u32 vcc, s64, v36
    s_mov_b32 s85, 0
    s_nop 0
    s_cbranch_vccnz LKV_oearly22
    buffer_load_dwordx4 a[0:3], v31, s[48:51], s82 offen sc1
    buffer_load_dwordx4 a[128:131], v32, s[48:51], s82 offen sc1
    s_add_u32 s82, s82, 1024
    s_and_b32 s82, s82, 8191
    buffer_load_dwordx4 a[4:7], v31, s[48:51], s82 offen sc1
    buffer_load_dwordx4 a[132:135], v32, s[48:51], s82 offen sc1
    s_add_u32 s82, s82, 1024
    s_and_b32 s82, s82, 8191
    buffer_load_dwordx4 a[8:11], v31, s[48:51], s82 offen sc1
    buffer_load_dwordx4 a[136:139], v32, s[48:51], s82 offen sc1
    s_add_u32 s82, s82, 1024
    s_and_b32 s82, s82, 8191
    buffer_load_dwordx4 a[12:15], v31, s[48:51], s82 offen sc1
    buffer_load_dwordx4 a[140:143], v32, s[48:51], s82 offen sc1
    s_add_u32 s82, s82, 1024
    s_and_b32 s82, s82, 8191
    buffer_load_dwordx4 a[16:19], v31, s[48:51], s82 offen sc1
    buffer_load_dwordx4 a[144:147], v32, s[48:51], s82 offen sc1
    s_add_u32 s82, s82, 1024
    s_and_b32 s82, s82, 8191
    buffer_load_dwordx4 a[20:23], v31, s[48:51], s82 offen sc1
    buffer_load_dwordx4 a[148:151], v32, s[48:51], s82 offen sc1
    s_add_u32 s82, s82, 1024
    s_and_b32 s82, s82, 8191
    buffer_load_dwordx4 a[24:27], v31, s[48:51], s82 offen sc1
    buffer_load_dwordx4 a[152:155], v32, s[48:51], s82 offen sc1
    s_add_u32 s82, s82, 1024
    s_and_b32 s82, s82, 8191
    buffer_load_dwordx4 a[28:31], v31, s[48:51], s82 offen sc1
    buffer_load_dwordx4 a[156:159], v32, s[48:51], s82 offen sc1
    s_mov_b32 s85, 1
LKV_oearly22:
    v_sub_f32 v56, 1.0, v38
    v_sub_f32 v57, 1.0, v39
    s_xor_b32 s68, s56, 1
    s_mul_i32 s68, s68, 22528
    s_add_u32 s68, s68, 4096
    v_lshl_add_u32 v61, v1, 4, s68
    s_xor_b32 s68, s56, 2
    s_mul_i32 s68, s68, 22528
    s_add_u32 s68, s68, 8192
    v_lshl_add_u32 v62, v1, 4, s68
    s_xor_b32 s68, s56, 3
    s_mul_i32 s68, s68, 22528
    s_add_u32 s68, s68, 12288
    v_lshl_add_u32 v63, v1, 4, s68
    s_add_u32 s68, s76, 4096
    v_lshl_add_u32 v60, v1, 4, s68
    s_lshl_b32 s68, s62, 6
    s_lshl_b32 s69, s61, 5
    s_add_u32 s68, s68, s69
    s_lshl_b32 s68, s68, 10
    s_lshl_b32 s69, s63, 7
    s_add_u32 s68, s68, s69
    s_lshl_b32 s69, s60, 6
    s_add_u32 s83, s68, s69
    v_and_b32 v58, 31, v1
    v_lshrrev_b32 v59, 5, v1
    s_mul_i32 s69, s61, 4608
    s_add_u32 s69, s69, 98304
    s_lshl_b32 s71, s60, 6
    s_add_u32 s71, s71, s69
    v_mul_u32_u24 v58, 144, v58
    v_lshl_add_u32 v58, v59, 3, v58
    v_add_u32 v4, s71, v58
    v_lshrrev_b32 v58, 3, v1
    s_lshl_b32 s71, s60, 4
    v_add_u32 v58, s71, v58
    v_and_b32 v59, 7, v1
    v_lshlrev_b32 v59, 4, v59
    v_mul_u32_u24 v5, 144, v58
    v_add3_u32 v5, v5, v59, s69
    v_lshl_add_u32 v58, v58, 10, v59
    v_add_u32 v59, 8192, v58
    s_mov_b32 s83, s68
    s_waitcnt lgkmcnt(7)
    v_mfma_f32_32x32x16_bf16 v[64:79], v[40:43], a[40:43], v[64:79]
    ds_read_b64_tr_b16 v[48:49], v27 offset:16384
    ds_read_b64_tr_b16 v[50:51], v27 offset:17408
    ds_read_b64_tr_b16 v[52:53], v28 offset:16384
    v_mfma_f32_32x32x16_bf16 v[80:95], v[40:43], a[168:171], v[80:95]
    ds_read_b64_tr_b16 v[54:55], v28 offset:17408
    ds_read_b64_tr_b16 a[58:59], v2 offset:9216
    ds_read_b64_tr_b16 a[184:185], v3 offset:8192
    v_mfma_f32_32x32x16_bf16 v[96:111], v[44:47], a[40:43], v[96:111]
    ds_read_b64_tr_b16 a[186:187], v3 offset:9216
    ds_read_b64_tr_b16 a[60:61], v2 offset:10240
    ds_read_b64_tr_b16 a[62:63], v2 offset:11264
    v_mfma_f32_32x32x16_bf16 v[112:127], v[44:47], a[168:171], v[112:127]
    ds_read_b64_tr_b16 a[188:189], v3 offset:10240
    ds_read_b64_tr_b16 a[190:191], v3 offset:11264
    s_waitcnt lgkmcnt(7)
    v_mfma_f32_32x32x16_bf16 v[64:79], v[48:51], a[44:47], v[64:79]
    ds_read_b64_tr_b16 v[40:41], v27 offset:18432
    ds_read_b64_tr_b16 v[42:43], v27 offset:19456
    ds_read_b64_tr_b16 v[44:45], v28 offset:18432
    v_mfma_f32_32x32x16_bf16 v[80:95], v[48:51], a[172:175], v[80:95]
    ds_read_b64_tr_b16 v[46:47], v28 offset:19456
    ds_read_b64_tr_b16 a[64:65], v2 offset:12288
    ds_read_b64_tr_b16 a[66:67], v2 offset:13312
    v_mfma_f32_32x32x16_bf16 v[96:111], v[52:55], a[44:47], v[96:111]
    ds_read_b64_tr_b16 a[192:193], v3 offset:12288
    ds_read_b64_tr_b16 a[194:195], v3 offset:13312
    ds_read_b64_tr_b16 a[68:69], v2 offset:14336
    v_mfma_f32_32x32x16_bf16 v[112:127], v[52:55], a[172:175], v[112:127]
    ds_read_b64_tr_b16 a[70:71], v2 offset:15360
    ds_read_b64_tr_b16 a[196:197], v3 offset:14336
    s_waitcnt lgkmcnt(7)
    v_mfma_f32_32x32x16_bf16 v[64:79], v[40:43], a[48:51], v[64:79]
    ds_read_b64_tr_b16 v[48:49], v27 offset:20480
    ds_read_b64_tr_b16 v[50:51], v27 offset:21504
    v_mfma_f32_32x32x16_bf16 v[80:95], v[40:43], a[176:179], v[80:95]
    ds_read_b64_tr_b16 v[52:53], v28 offset:20480
    v_mfma_f32_32x32x16_bf16 v[96:111], v[44:47], a[48:51], v[96:111]
    ds_read_b64_tr_b16 v[54:55], v28 offset:21504
    v_mfma_f32_32x32x16_bf16 v[112:127], v[44:47], a[176:179], v[112:127]
    ds_read_b64_tr_b16 a[198:199], v3 offset:15360
    s_cmp_ge_u32 s56, 2
    s_cbranch_scc1 LKV_s2123
    s_waitcnt lgkmcnt(1)
    v_mfma_f32_32x32x16_bf16 v[64:79], v[48:51], a[52:55], v[64:79]
    v_mfma_f32_32x32x16_bf16 v[80:95], v[48:51], a[180:183], v[80:95]
    v_mfma_f32_32x32x16_bf16 v[96:111], v[52:55], a[52:55], v[96:111]
    v_mfma_f32_32x32x16_bf16 v[112:127], v[52:55], a[180:183], v[112:127]
LKV_s2123:
    s_cmp_lg_u32 s85, 0
    s_cbranch_scc0 LKV_olate24_ool5
LKV_olate24:
    s_waitcnt lgkmcnt(0)
    s_barrier
    s_waitcnt vmcnt(14)
    v_mfma_f32_32x32x16_bf16 v[176:191], v[132:135], a[0:3], 0
    s_nop 3
    v_mul_f32 v80, v57, v80
    v_mul_f32 v81, v57, v81
    v_mul_f32 v82, v57, v82
    v_mul_f32 v83, v57, v83
    v_mul_f32 v84, v57, v84
    v_mfma_f32_32x32x16_bf16 v[160:175], v[128:131], a[0:3], 0
    v_mul_f32 v85, v57, v85
    v_mul_f32 v86, v57, v86
    v_mul_f32 v87, v57, v87
    v_mul_f32 v88, v57, v88
    v_mul_f32 v89, v57, v89
    v_mfma_f32_32x32x16_bf16 v[176:191], v[228:231], a[128:131], v[176:191]
    v_mul_f32 v90, v57, v90
    v_mul_f32 v91, v57, v91
    v_mul_f32 v92, v57, v92
    v_mul_f32 v93, v57, v93
    v_mul_f32 v94, v57, v94
    v_mfma_f32_32x32x16_bf16 v[160:175], v[224:227], a[128:131], v[160:175]
    v_mul_f32 v95, v57, v95
    ds_write_b128 v61, v[80:83] offset:0
    ds_write_b128 v61, v[84:87] offset:1024
    ds_write_b128 v61, v[88:91] offset:2048
    ds_write_b128 v61, v[92:95] offset:3072
    s_waitcnt vmcnt(12)
    v_mfma_f32_32x32x16_bf16 v[176:191], v[140:143], a[4:7], v[176:191]
    v_mul_f32 v112, v57, v112
    v_mul_f32 v113, v57, v113
    v_mul_f32 v114, v57, v114
    v_mul_f32 v115, v57, v115
    v_mul_f32 v116, v57, v116
    v_mfma_f32_32x32x16_bf16 v[160:175], v[136:139], a[4:7], v[160:175]
    v_mul_f32 v117, v57, v117
    v_mul_f32 v118, v57, v118
    v_mul_f32 v119, v57, v119
    v_mul_f32 v120, v57, v120
    v_mul_f32 v121, v57, v121
    v_mfma_f32_32x32x16_bf16 v[176:191], v[236:239], a[132:135], v[176:191]
    v_mul_f32 v122, v57, v122
    v_mul_f32 v123, v57, v123
    v_mul_f32 v124, v57, v124
    v_mul_f32 v125, v57, v125
    v_mul_f32 v126, v57, v126
    v_mfma_f32_32x32x16_bf16 v[160:175], v[232:235], a[132:135], v[160:175]
    v_mul_f32 v127, v57, v127
    ds_write_b128 v63, v[112:115] offset:0
    ds_write_b128 v63, v[116:119] offset:1024
    ds_write_b128 v63, v[120:123] offset:2048
    ds_write_b128 v63, v[124:127] offset:3072
    s_waitcnt vmcnt(10)
    v_mfma_f32_32x32x16_bf16 v[176:191], v[148:151], a[8:11], v[176:191]
    v_mul_f32 v96, v56, v96
    v_mul_f32 v97, v56, v97
    v_mul_f32 v98, v56, v98
    v_mul_f32 v99, v56, v99
    v_mul_f32 v100, v56, v100
    v_mfma_f32_32x32x16_bf16 v[176:191], v[244:247], a[136:139], v[176:191]
    v_mul_f32 v101, v56, v101
    v_mul_f32 v102, v56, v102
    v_mul_f32 v103, v56, v103
    v_mul_f32 v104, v56, v104
    v_mul_f32 v105, v56, v105
    s_waitcnt vmcnt(8)
    v_mfma_f32_32x32x16_bf16 v[176:191], v[156:159], a[12:15], v[176:191]
    v_mul_f32 v106, v56, v106
    v_mul_f32 v107, v56, v107
    v_mul_f32 v108, v56, v108
    v_mul_f32 v109, v56, v109
    v_mul_f32 v110, v56, v110
    v_mfma_f32_32x32x16_bf16 v[176:191], v[252:255], a[140:143], v[176:191]
    v_mul_f32 v111, v56, v111
    s_waitcnt lgkmcnt(0)
    s_barrier
    ds_read_b128 v[80:83], v60 offset:0
    ds_read_b128 v[84:87], v60 offset:1024
    s_waitcnt vmcnt(6)
    v_mfma_f32_32x32x16_bf16 v[176:191], v[196:199], a[16:19], v[176:191]
    ds_read_b128 v[88:91], v60 offset:2048
    ds_read_b128 v[92:95], v60 offset:3072
    ds_read_b128 v[112:115], v60 offset:8192
    ds_read_b128 v[116:119], v60 offset:9216
    ds_read_b128 v[120:123], v60 offset:10240
    v_mfma_f32_32x32x16_bf16 v[176:191], a[184:187], a[144:147], v[176:191]
    ds_read_b128 v[124:127], v60 offset:11264
    v_mul_f32 v64, v56, v64
    v_mul_f32 v65, v56, v65
    v_mul_f32 v66, v56, v66
    v_mul_f32 v67, v56, v67
    s_waitcnt vmcnt(4)
    v_mfma_f32_32x32x16_bf16 v[176:191], v[204:207], a[20:23], v[176:191]
    v_mul_f32 v68, v56, v68
    v_mul_f32 v69, v56, v69
    v_mul_f32 v70, v56, v70
    v_mul_f32 v71, v56, v71
    v_mul_f32 v72, v56, v72
    v_mfma_f32_32x32x16_bf16 v[176:191], a[188:191], a[148:151], v[176:191]
    v_mul_f32 v73, v56, v73
    v_mul_f32 v74, v56, v74
    v_mul_f32 v75, v56, v75
    v_mul_f32 v76, v56, v76
    v_mul_f32 v77, v56, v77
    s_waitcnt vmcnt(2)
    v_mfma_f32_32x32x16_bf16 v[176:191], v[212:215], a[24:27], v[176:191]
    v_mul_f32 v78, v56, v78
    v_mul_f32 v79, v56, v79
    v_mfma_f32_32x32x16_bf16 v[176:191], a[192:195], a[152:155], v[176:191]
    s_waitcnt vmcnt(0)
    v_mfma_f32_32x32x16_bf16 v[176:191], v[220:223], a[28:31], v[176:191]
    v_mfma_f32_32x32x16_bf16 v[176:191], a[196:199], a[156:159], v[176:191]
    v_mfma_f32_32x32x16_bf16 v[160:175], v[144:147], a[8:11], v[160:175]
    s_waitcnt lgkmcnt(4)
    v_add_f32 v64, v64, v80
    v_add_f32 v65, v65, v81
    v_add_f32 v66, v66, v82
    v_add_f32 v67, v67, v83
    v_add_f32 v68, v68, v84
    v_mfma_f32_32x32x16_bf16 v[160:175], v[240:243], a[136:139], v[160:175]
    v_add_f32 v69, v69, v85
    v_add_f32 v70, v70, v86
    v_add_f32 v71, v71, v87
    v_add_f32 v72, v72, v88
    v_add_f32 v73, v73, v89
    v_add_f32 v74, v74, v90
    v_mfma_f32_32x32x16_bf16 v[160:175], v[152:155], a[12:15], v[160:175]
    v_add_f32 v75, v75, v91
    v_add_f32 v76, v76, v92
    v_add_f32 v77, v77, v93
    v_add_f32 v78, v78, v94
    v_add_f32 v79, v79, v95
    s_waitcnt lgkmcnt(0)
    v_mfma_f32_32x32x16_bf16 v[160:175], v[248:251], a[140:143], v[160:175]
    v_fmac_f32 v96, v38, v176
    v_fmac_f32 v97, v38, v177
    v_fmac_f32 v98, v38, v178
    v_fmac_f32 v99, v38, v179
    ds_write_b128 v62, v[96:99] offset:0
    v_mfma_f32_32x32x16_bf16 v[160:175], v[192:195], a[16:19], v[160:175]
    v_fmac_f32 v100, v38, v180
    v_fmac_f32 v101, v38, v181
    v_fmac_f32 v102, v38, v182
    v_fmac_f32 v103, v38, v183
    ds_write_b128 v62, v[100:103] offset:1024
    v_mfma_f32_32x32x16_bf16 v[160:175], a[56:59], a[144:147], v[160:175]
    v_fmac_f32 v104, v38, v184
    v_fmac_f32 v105, v38, v185
    v_fmac_f32 v106, v38, v186
    v_fmac_f32 v107, v38, v187
    ds_write_b128 v62, v[104:107] offset:2048
    v_mfma_f32_32x32x16_bf16 v[160:175], v[200:203], a[20:23], v[160:175]
    v_fmac_f32 v108, v38, v188
    v_fmac_f32 v109, v38, v189
    v_fmac_f32 v110, v38, v190
    v_fmac_f32 v111, v38, v191
    ds_write_b128 v62, v[108:111] offset:3072
    v_mfma_f32_32x32x16_bf16 v[160:175], a[60:63], a[148:151], v[160:175]
    v_add_f32 v64, v64, v112
    v_add_f32 v65, v65, v113
    v_add_f32 v66, v66, v114
    v_add_f32 v67, v67, v115
    v_add_f32 v68, v68, v116
    v_add_f32 v69, v69, v117
    s_waitcnt lgkmcnt(0)
    s_barrier
    v_mfma_f32_32x32x16_bf16 v[160:175], v[208:211], a[24:27], v[160:175]
    ds_read_b128 v[96:99], v60 offset:4096
    ds_read_b128 v[100:103], v60 offset:5120
    ds_read_b128 v[104:107], v60 offset:6144
    ds_read_b128 v[108:111], v60 offset:7168
    v_mfma_f32_32x32x16_bf16 v[160:175], a[64:67], a[152:155], v[160:175]
    v_add_f32 v70, v70, v118
    v_add_f32 v71, v71, v119
    v_add_f32 v72, v72, v120
    v_add_f32 v73, v73, v121
    v_add_f32 v74, v74, v122
    v_add_f32 v75, v75, v123
    v_mfma_f32_32x32x16_bf16 v[160:175], v[216:219], a[28:31], v[160:175]
    v_add_f32 v76, v76, v124
    v_add_f32 v77, v77, v125
    v_add_f32 v78, v78, v126
    v_add_f32 v79, v79, v127
    v_mfma_f32_32x32x16_bf16 v[160:175], a[68:71], a[156:159], v[160:175]
    s_waitcnt lgkmcnt(0)
    v_pk_add_f32 v[64:65], v[64:65], v[96:97]
    v_pk_add_f32 v[66:67], v[66:67], v[98:99]
    v_pk_add_f32 v[68:69], v[68:69], v[100:101]
    v_pk_add_f32 v[70:71], v[70:71], v[102:103]
    v_pk_add_f32 v[72:73], v[72:73], v[104:105]
    v_pk_add_f32 v[74:75], v[74:75], v[106:107]
    v_pk_add_f32 v[76:77], v[76:77], v[108:109]
    v_pk_add_f32 v[78:79], v[78:79], v[110:111]
    s_nop 2
    v_pk_fma_f32 v[64:65], v[160:161], v[38:39], v[64:65] op_sel_hi:[1,0,1]
    v_pk_fma_f32 v[66:67], v[162:163], v[38:39], v[66:67] op_sel_hi:[1,0,1]
    v_pk_fma_f32 v[68:69], v[164:165], v[38:39], v[68:69] op_sel_hi:[1,0,1]
    v_pk_fma_f32 v[70:71], v[166:167], v[38:39], v[70:71] op_sel_hi:[1,0,1]
    v_pk_fma_f32 v[72:73], v[168:169], v[38:39], v[72:73] op_sel_hi:[1,0,1]
    v_pk_fma_f32 v[74:75], v[170:171], v[38:39], v[74:75] op_sel_hi:[1,0,1]
    v_pk_fma_f32 v[76:77], v[172:173], v[38:39], v[76:77] op_sel_hi:[1,0,1]
    v_pk_fma_f32 v[78:79], v[174:175], v[38:39], v[78:79] op_sel_hi:[1,0,1]
    v_cvt_pk_bf16_f32 v80, v64, v65
    v_cvt_pk_bf16_f32 v81, v66, v67
    v_cvt_pk_bf16_f32 v82, v68, v69
    v_cvt_pk_bf16_f32 v83, v70, v71
    v_cvt_pk_bf16_f32 v84, v72, v73
    v_cvt_pk_bf16_f32 v85, v74, v75
    v_cvt_pk_bf16_f32 v86, v76, v77
    v_cvt_pk_bf16_f32 v87, v78, v79
    ds_write_b64 v4, v[80:81] offset:0
    ds_write_b64 v4, v[82:83] offset:16
    ds_write_b64 v4, v[84:85] offset:32
    ds_write_b64 v4, v[86:87] offset:48
    s_waitcnt lgkmcnt(0)
    s_barrier
    ds_read_b128 v[80:83], v5
    ds_read_b128 v[84:87], v5 offset:1152
    s_waitcnt lgkmcnt(1)
    buffer_store_dwordx4 v[80:83], v58, s[52:55], s83 offen sc0 sc1
    s_waitcnt lgkmcnt(0)
    buffer_store_dwordx4 v[84:87], v59, s[52:55], s83 offen sc0 sc1
    s_endpgm
LKV_nd6_ool1:
    s_mov_b32 s72, 400000
LKV_nl5:
    v_mov_b32 v36, 0
    global_load_dword v36, v36, s[22:23] sc1
    s_waitcnt vmcnt(0)
    s_sub_u32 s72, s72, 1
    s_cbranch_scc1 LKV_nx7
    v_readfirstlane_b32 s64, v36
    s_nop 3
    s_cmp_eq_u32 s64, 0
    s_cbranch_scc1 LKV_nl5
LKV_nx7:
    s_branch LKV_nd6
LKV_pdone9_ool2:
    s_mov_b32 s72, 400000
LKV_poll8:
    buffer_load_dword v36, v35, s[48:51], s27 offen offset:0 sc1
    s_waitcnt vmcnt(0)
    s_sub_u32 s72, s72, 1
    s_cbranch_scc1 LKV_px10
    v_cmp_ne_u32 vcc, s64, v36
    s_nop 1
    s_cbranch_vccnz LKV_poll8
LKV_px10:
    s_branch LKV_pdone9
LKV_pdone15_ool3:
    s_mov_b32 s72, 400000
LKV_poll14:
    buffer_load_dword v36, v35, s[48:51], s101 offen offset:0 sc1
    s_waitcnt vmcnt(0)
    s_sub_u32 s72, s72, 1
    s_cbranch_scc1 LKV_px16
    v_cmp_ne_u32 vcc, s64, v36
    s_nop 1
    s_cbranch_vccnz LKV_poll14
LKV_px16:
    s_branch LKV_pdone15
LKV_pdone19_ool4:
    s_mov_b32 s72, 400000
LKV_poll18:
    buffer_load_dword v36, v35, s[48:51], s27 offen offset:0 sc1
    s_waitcnt vmcnt(0)
    s_sub_u32 s72, s72, 1
    s_cbranch_scc1 LKV_px20
    v_cmp_ne_u32 vcc, s64, v36
    s_nop 1
    s_cbranch_vccnz LKV_poll18
LKV_px20:
    s_branch LKV_pdone19
LKV_olate24_ool5:
    s_waitcnt vmcnt(0)
    v_cmp_ne_u32 vcc, s64, v36
    s_nop 1
    s_cbranch_vccz LKV_pdone26
    s_mov_b32 s72, 400000
LKV_poll25:
    buffer_load_dword v36, v35, s[48:51], s27 offen offset:0 sc1
    s_waitcnt vmcnt(0)
    s_sub_u32 s72, s72, 1
    s_cbranch_scc1 LKV_px27
    v_cmp_ne_u32 vcc, s64, v36
    s_nop 1
    s_cbranch_vccnz LKV_poll25
LKV_px27:
LKV_pdone26:
    buffer_load_dwordx4 a[0:3], v31, s[48:51], s82 offen sc1
    buffer_load_dwordx4 a[128:131], v32, s[48:51], s82 offen sc1
    s_add_u32 s82, s82, 1024
    s_and_b32 s82, s82, 8191
    buffer_load_dwordx4 a[4:7], v31, s[48:51], s82 offen sc1
    buffer_load_dwordx4 a[132:135], v32, s[48:51], s82 offen sc1
    s_add_u32 s82, s82, 1024
    s_and_b32 s82, s82, 8191
    buffer_load_dwordx4 a[8:11], v31, s[48:51], s82 offen sc1
    buffer_load_dwordx4 a[136:139], v32, s[48:51], s82 offen sc1
    s_add_u32 s82, s82, 1024
    s_and_b32 s82, s82, 8191
    buffer_load_dwordx4 a[12:15], v31, s[48:51], s82 offen sc1
    buffer_load_dwordx4 a[140:143], v32, s[48:51], s82 offen sc1
    s_add_u32 s82, s82, 1024
    s_and_b32 s82, s82, 8191
    buffer_load_dwordx4 a[16:19], v31, s[48:51], s82 offen sc1
    buffer_load_dwordx4 a[144:147], v32, s[48:51], s82 offen sc1
    s_add_u32 s82, s82, 1024
    s_and_b32 s82, s82, 8191
    buffer_load_dwordx4 a[20:23], v31, s[48:51], s82 offen sc1
    buffer_load_dwordx4 a[148:151], v32, s[48:51], s82 offen sc1
    s_add_u32 s82, s82, 1024
    s_and_b32 s82, s82, 8191
    buffer_load_dwordx4 a[24:27], v31, s[48:51], s82 offen sc1
    buffer_load_dwordx4 a[152:155], v32, s[48:51], s82 offen sc1
    s_add_u32 s82, s82, 1024
    s_and_b32 s82, s82, 8191
    buffer_load_dwordx4 a[28:31], v31, s[48:51], s82 offen sc1
    buffer_load_dwordx4 a[156:159], v32, s[48:51], s82 offen sc1
    s_branch LKV_olate24
.p2align 6
L_Q:
    s_mov_b32 s36, s6
    s_mov_b32 s37, s7
    s_mov_b32 s38, 1572864
    s_mov_b32 s39, 0x20000
    s_lshl_b32 s68, s58, 7
    s_mul_i32 s69, s56, 49152
    s_add_u32 s68, s68, s69
    v_mul_u32_u24 v60, 3072, v60
    v_add3_u32 v10, v60, v63, s68
    v_add_u32 v11, 23552, v10
    buffer_load_dwordx4 v5, s[28:31], s66 offen offset:3072 lds
    s_lshr_b32 s67, s66, 7
    s_add_u32 m0, s74, 32768
    s_mul_i32 s67, s67, s85
    buffer_load_dwordx4 v6, s[32:35], s67 offen offset:0 lds
    buffer_load_dwordx4 v7, s[32:35], s67 offen offset:1024 lds
    buffer_load_dwordx4 v8, s[32:35], s67 offen offset:2048 lds
    buffer_load_dwordx4 v9, s[32:35], s67 offen offset:3072 lds
    s_waitcnt vmcnt(8)
    s_barrier
    ds_read_b64_tr_b16 v[240:241], v36 offset:0
    ds_read_b64_tr_b16 v[242:243], v36 offset:256
    ds_read_b64_tr_b16 v[244:245], v36 offset:512
    ds_read_b64_tr_b16 v[246:247], v36 offset:768
    ds_read_b64_tr_b16 v[40:41], v22 offset:0
    ds_read_b64_tr_b16 v[42:43], v22 offset:1024
    ds_read_b128 a[0:3], v14 offset:0
    ds_read_b64_tr_b16 v[44:45], v23 offset:0
    ds_read_b64_tr_b16 v[46:47], v23 offset:1024
    ds_read_b128 a[128:131], v14 offset:4096
    s_waitcnt lgkmcnt(6)
    v_xor_b32 v240, v38, v240
    v_xor_b32 v241, v38, v241
    v_xor_b32 v242, v38, v242
    v_xor_b32 v243, v38, v243
    v_xor_b32 v244, v38, v244
    v_xor_b32 v245, v38, v245
    v_xor_b32 v246, v38, v246
    v_xor_b32 v247, v38, v247
    s_waitcnt lgkmcnt(0)
    v_mfma_f32_32x32x16_bf16 v[64:79], v[40:43], a[0:3], 0
    ds_read_b64_tr_b16 v[48:49], v22 offset:4096
    ds_read_b64_tr_b16 v[50:51], v22 offset:5120
    ds_read_b128 a[4:7], v15 offset:0
    ds_read_b64_tr_b16 v[52:53], v23 offset:4096
    s_add_u32 m0, s73, 65536
    s_add_u32 s66, s59, 2
    s_and_b32 s66, s66, 7
    s_lshl_b32 s66, s66, 7
    buffer_load_dwordx4 v2, s[28:31], s66 offen offset:0 lds
    v_mfma_f32_32x32x16_bf16 v[80:95], v[40:43], a[128:131], 0
    ds_read_b64_tr_b16 v[54:55], v23 offset:5120
    ds_read_b128 a[132:135], v15 offset:4096
    buffer_load_dwordx4 v3, s[28:31], s66 offen offset:1024 lds
    v_mfma_f32_32x32x16_bf16 v[96:111], v[44:47], a[0:3], 0
    v_mfma_f32_32x32x16_bf16 v[112:127], v[44:47], a[128:131], 0
    buffer_load_dwordx4 v4, s[28:31], s66 offen offset:2048 lds
    s_waitcnt lgkmcnt(0)
    v_mfma_f32_32x32x16_bf16 v[64:79], v[48:51], a[4:7], v[64:79]
    ds_read_b64_tr_b16 v[40:41], v22 offset:8192
    ds_read_b64_tr_b16 v[42:43], v22 offset:9216
    ds_read_b128 a[8:11], v16 offset:0
    ds_read_b64_tr_b16 v[44:45], v23 offset:8192
    buffer_load_dwordx4 v5, s[28:31], s66 offen offset:3072 lds
    v_mfma_f32_32x32x16_bf16 v[80:95], v[48:51], a[132:135], v[80:95]
    ds_read_b64_tr_b16 v[46:47], v23 offset:9216
    ds_read_b128 a[136:139], v16 offset:4096
    s_lshr_b32 s67, s66, 7
    s_add_u32 m0, s74, 65536
    s_mul_i32 s67, s67, s85
    buffer_load_dwordx4 v6, s[32:35], s67 offen offset:0 lds
    v_mfma_f32_32x32x16_bf16 v[96:111], v[52:55], a[4:7], v[96:111]
    v_mfma_f32_32x32x16_bf16 v[112:127], v[52:55], a[132:135], v[112:127]
    buffer_load_dwordx4 v7, s[32:35], s67 offen offset:1024 lds
    s_waitcnt lgkmcnt(0)
    v_mfma_f32_32x32x16_bf16 v[64:79], v[40:43], a[8:11], v[64:79]
    ds_read_b64_tr_b16 v[48:49], v22 offset:12288
    ds_read_b64_tr_b16 v[50:51], v22 offset:13312
    ds_read_b128 a[12:15], v17 offset:0
    ds_read_b64_tr_b16 v[52:53], v23 offset:12288
    buffer_load_dwordx4 v8, s[32:35], s67 offen offset:2048 lds
    v_mfma_f32_32x32x16_bf16 v[80:95], v[40:43], a[136:139], v[80:95]
    ds_read_b64_tr_b16 v[54:55], v23 offset:13312
    ds_read_b128 a[140:143], v17 offset:4096
    buffer_load_dwordx4 v9, s[32:35], s67 offen offset:3072 lds
    v_mfma_f32_32x32x16_bf16 v[96:111], v[44:47], a[8:11], v[96:111]
    v_mfma_f32_32x32x16_bf16 v[112:127], v[44:47], a[136:139], v[112:127]
    s_waitcnt lgkmcnt(0)
    s_waitcnt vmcnt(8)
    s_barrier
    v_mfma_f32_32x32x16_bf16 v[64:79], v[48:51], a[12:15], v[64:79]
    ds_read_b64_tr_b16 v[40:41], v22 offset:32768
    ds_read_b64_tr_b16 v[42:43], v22 offset:33792
    ds_read_b128 a[16:19], v14 offset:32768
    ds_read_b64_tr_b16 v[44:45], v23 offset:32768
    v_mfma_f32_32x32x16_bf16 v[80:95], v[48:51], a[140:143], v[80:95]
    ds_read_b64_tr_b16 v[46:47], v23 offset:33792
    ds_read_b128 a[144:147], v14 offset:36864
    v_mfma_f32_32x32x16_bf16 v[96:111], v[52:55], a[12:15], v[96:111]
    s_add_u32 m0, s73, 0
    s_add_u32 s66, s59, 3
    s_and_b32 s66, s66, 7
    s_lshl_b32 s66, s66, 7
    buffer_load_dwordx4 v2, s[28:31], s66 offen offset:0 lds
    v_mfma_f32_32x32x16_bf16 v[112:127], v[52:55], a[140:143], v[112:127]
    buffer_load_dwordx4 v3, s[28:31], s66 offen offset:1024 lds
    s_waitcnt lgkmcnt(0)
    v_mfma_f32_32x32x16_bf16 v[64:79], v[40:43], a[16:19], v[64:79]
    ds_read_b64_tr_b16 v[48:49], v22 offset:36864
    ds_read_b64_tr_b16 v[50:51], v22 offset:37888
    ds_read_b128 a[20:23], v15 offset:32768
    ds_read_b64_tr_b16 v[52:53], v23 offset:36864
    v_mfma_f32_32x32x16_bf16 v[80:95], v[40:43], a[144:147], v[80:95]
    ds_read_b64_tr_b16 v[54:55], v23 offset:37888
    ds_read_b128 a[148:151], v15 offset:36864
    v_mfma_f32_32x32x16_bf16 v[96:111], v[44:47], a[16:19], v[96:111]
    buffer_load_dwordx4 v4, s[28:31], s66 offen offset:2048 lds
    v_mfma_f32_32x32x16_bf16 v[112:127], v[44:47], a[144:147], v[112:127]
    buffer_load_dwordx4 v5, s[28:31], s66 offen offset:3072 lds
    s_waitcnt lgkmcnt(0)
    v_mfma_f32_32x32x16_bf16 v[64:79], v[48:51], a[20:23], v[64:79]
    ds_read_b64_tr_b16 v[40:41], v22 offset:40960
    ds_read_b64_tr_b16 v[42:43], v22 offset:41984
    ds_read_b128 a[24:27], v16 offset:32768
    ds_read_b64_tr_b16 v[44:45], v23 offset:40960
    v_mfma_f32_32x32x16_bf16 v[80:95], v[48:51], a[148:151], v[80:95]
    ds_read_b64_tr_b16 v[46:47], v23 offset:41984
    ds_read_b128 a[152:155], v16 offset:36864
    v_mfma_f32_32x32x16_bf16 v[96:111], v[52:55], a[20:23], v[96:111]
    s_lshr_b32 s67, s66, 7
    s_add_u32 m0, s74, 0
    s_mul_i32 s67, s67, s85
    buffer_load_dwordx4 v6, s[32:35], s67 offen offset:0 lds
    v_mfma_f32_32x32x16_bf16 v[112:127], v[52:55], a[148:151], v[112:127]
    buffer_load_dwordx4 v7, s[32:35], s67 offen offset:1024 lds
    s_waitcnt lgkmcnt(0)
    v_mfma_f32_32x32x16_bf16 v[64:79], v[40:43], a[24:27], v[64:79]
    ds_read_b64_tr_b16 v[48:49], v22 offset:45056
    ds_read_b64_tr_b16 v[50:51], v22 offset:46080
    ds_read_b128 a[28:31], v17 offset:32768
    ds_read_b64_tr_b16 v[52:53], v23 offset:45056
    v_mfma_f32_32x32x16_bf16 v[80:95], v[40:43], a[152:155], v[80:95]
    ds_read_b64_tr_b16 v[54:55], v23 offset:46080
    ds_read_b128 a[156:159], v17 offset:36864
    v_mfma_f32_32x32x16_bf16 v[96:111], v[44:47], a[24:27], v[96:111]
    buffer_load_dwordx4 v8, s[32:35], s67 offen offset:2048 lds
    v_mfma_f32_32x32x16_bf16 v[112:127], v[44:47], a[152:155], v[112:127]
    buffer_load_dwordx4 v9, s[32:35], s67 offen offset:3072 lds
    s_waitcnt lgkmcnt(0)
    s_waitcnt vmcnt(8)
    s_barrier
    s_lshl_b32 s69, s2, 2
    s_add_u32 s69, s69, s56
    s_lshr_b32 s70, s69, 1
    s_and_b32 s69, s69, 1
    s_mul_i32 s71, s70, 3072
    s_lshl_b32 s68, s69, 9
    s_add_u32 s71, s71, s68
    v_lshl_add_u32 v58, v1, 7, s71
    s_mul_i32 s71, s70, 2752
    s_mul_i32 s68, s69, 384
    s_add_u32 s71, s71, s68
    s_add_u32 s71, s71, 2048
    v_lshl_add_u32 v59, v1, 7, s71
    s_mov_b64 exec, 15
    buffer_load_dword v0, v58, s[36:39], 0 offen
    s_mov_b64 exec, 7
    buffer_load_dword v0, v59, s[32:35], 0 offen
    s_mov_b64 exec, -1
    v_mfma_f32_32x32x16_bf16 v[64:79], v[48:51], a[28:31], v[64:79]
    ds_read_b64_tr_b16 v[40:41], v24 offset:0
    ds_read_b64_tr_b16 v[42:43], v24 offset:1024
    ds_read_b128 a[32:35], v18 offset:0
    ds_read_b64_tr_b16 v[44:45], v25 offset:0
    v_mfma_f32_32x32x16_bf16 v[80:95], v[48:51], a[156:159], v[80:95]
    ds_read_b64_tr_b16 v[46:47], v25 offset:1024
    ds_read_b128 a[160:163], v18 offset:4096
    v_mfma_f32_32x32x16_bf16 v[96:111], v[52:55], a[28:31], v[96:111]
    s_add_u32 m0, s73, 32768
    s_add_u32 s66, s59, 4
    s_and_b32 s66, s66, 7
    s_lshl_b32 s66, s66, 7
    buffer_load_dwordx4 v2, s[28:31], s66 offen offset:0 lds
    v_mfma_f32_32x32x16_bf16 v[112:127], v[52:55], a[156:159], v[112:127]
    buffer_load_dwordx4 v3, s[28:31], s66 offen offset:1024 lds
    s_waitcnt lgkmcnt(0)
    v_mfma_f32_32x32x16_bf16 v[64:79], v[40:43], a[32:35], v[64:79]
    ds_read_b64_tr_b16 v[48:49], v24 offset:4096
    ds_read_b64_tr_b16 v[50:51], v24 offset:5120
    ds_read_b128 a[36:39], v19 offset:0
    ds_read_b64_tr_b16 v[52:53], v25 offset:4096
    v_mfma_f32_32x32x16_bf16 v[80:95], v[40:43], a[160:163], v[80:95]
    ds_read_b64_tr_b16 v[54:55], v25 offset:5120
    ds_read_b128 a[164:167], v19 offset:4096
    v_mfma_f32_32x32x16_bf16 v[96:111], v[44:47], a[32:35], v[96:111]
    buffer_load_dwordx4 v4, s[28:31], s66 offen offset:2048 lds
    v_mfma_f32_32x32x16_bf16 v[112:127], v[44:47], a[160:163], v[112:127]
    buffer_load_dwordx4 v5, s[28:31], s66 offen offset:3072 lds
    s_waitcnt lgkmcnt(0)
    v_mfma_f32_32x32x16_bf16 v[64:79], v[48:51], a[36:39], v[64:79]
    ds_read_b64_tr_b16 v[40:41], v24 offset:8192
    ds_read_b64_tr_b16 v[42:43], v24 offset:9216
    ds_read_b128 a[40:43], v20 offset:0
    ds_read_b64_tr_b16 v[44:45], v25 offset:8192
    v_mfma_f32_32x32x16_bf16 v[80:95], v[48:51], a[164:167], v[80:95]
    ds_read_b64_tr_b16 v[46:47], v25 offset:9216
    ds_read_b128 a[168:171], v20 offset:4096
    v_mfma_f32_32x32x16_bf16 v[96:111], v[52:55], a[36:39], v[96:111]
    s_lshr_b32 s67, s66, 7
    s_add_u32 m0, s74, 32768
    s_mul_i32 s67, s67, s85
    buffer_load_dwordx4 v6, s[32:35], s67 offen offset:0 lds
    v_mfma_f32_32x32x16_bf16 v[112:127], v[52:55], a[164:167], v[112:127]
    buffer_load_dwordx4 v7, s[32:35], s67 offen offset:1024 lds
    s_waitcnt lgkmcnt(0)
    v_mfma_f32_32x32x16_bf16 v[64:79], v[40:43], a[40:43], v[64:79]
    ds_read_b64_tr_b16 v[48:49], v24 offset:12288
    ds_read_b64_tr_b16 v[50:51], v24 offset:13312
    ds_read_b128 a[44:47], v21 offset:0
    ds_read_b64_tr_b16 v[52:53], v25 offset:12288
    v_mfma_f32_32x32x16_bf16 v[80:95], v[40:43], a[168:171], v[80:95]
    ds_read_b64_tr_b16 v[54:55], v25 offset:13312
    ds_read_b128 a[172:175], v21 offset:4096
    v_mfma_f32_32x32x16_bf16 v[96:111], v[44:47], a[40:43], v[96:111]
    buffer_load_dwordx4 v8, s[32:35], s67 offen offset:2048 lds
    v_mfma_f32_32x32x16_bf16 v[112:127], v[44:47], a[168:171], v[112:127]
    buffer_load_dwordx4 v9, s[32:35], s67 offen offset:3072 lds
    s_waitcnt lgkmcnt(0)
    s_waitcnt vmcnt(10)
    s_barrier
    v_mfma_f32_32x32x16_bf16 v[64:79], v[48:51], a[44:47], v[64:79]
    ds_read_b64_tr_b16 v[40:41], v22 offset:0
    ds_read_b64_tr_b16 v[42:43], v22 offset:1024
    ds_read_b128 a[48:51], v14 offset:0
    ds_read_b64_tr_b16 v[44:45], v23 offset:0
    v_mfma_f32_32x32x16_bf16 v[80:95], v[48:51], a[172:175], v[80:95]
    ds_read_b64_tr_b16 v[46:47], v23 offset:1024
    ds_read_b128 a[176:179], v14 offset:4096
    v_mfma_f32_32x32x16_bf16 v[96:111], v[52:55], a[44:47], v[96:111]
    s_add_u32 m0, s73, 65536
    s_add_u32 s66, s59, 5
    s_and_b32 s66, s66, 7
    s_lshl_b32 s66, s66, 7
    buffer_load_dwordx4 v2, s[28:31], s66 offen offset:0 lds
    v_mfma_f32_32x32x16_bf16 v[112:127], v[52:55], a[172:175], v[112:127]
    buffer_load_dwordx4 v3, s[28:31], s66 offen offset:1024 lds
    s_waitcnt lgkmcnt(0)
    v_mfma_f32_32x32x16_bf16 v[64:79], v[40:43], a[48:51], v[64:79]
    ds_read_b64_tr_b16 v[48:49], v22 offset:4096
    ds_read_b64_tr_b16 v[50:51], v22 offset:5120
    ds_read_b128 a[52:55], v15 offset:0
    ds_read_b64_tr_b16 v[52:53], v23 offset:4096
    v_mfma_f32_32x32x16_bf16 v[80:95], v[40:43], a[176:179], v[80:95]
    ds_read_b64_tr_b16 v[54:55], v23 offset:5120
    ds_read_b128 a[180:183], v15 offset:4096
    v_mfma_f32_32x32x16_bf16 v[96:111], v[44:47], a[48:51], v[96:111]
    buffer_load_dwordx4 v4, s[28:31], s66 offen offset:2048 lds
    v_mfma_f32_32x32x16_bf16 v[112:127], v[44:47], a[176:179], v[112:127]
    buffer_load_dwordx4 v5, s[28:31], s66 offen offset:3072 lds
    s_waitcnt lgkmcnt(0)
    v_mfma_f32_32x32x16_bf16 v[64:79], v[48:51], a[52:55], v[64:79]
    ds_read_b64_tr_b16 v[40:41], v22 offset:8192
    ds_read_b64_tr_b16 v[42:43], v22 offset:9216
    ds_read_b128 a[56:59], v16 offset:0
    ds_read_b64_tr_b16 v[44:45], v23 offset:8192
    v_mfma_f32_32x32x16_bf16 v[80:95], v[48:51], a[180:183], v[80:95]
    ds_read_b64_tr_b16 v[46:47], v23 offset:9216
    ds_read_b128 a[184:187], v16 offset:4096
    v_mfma_f32_32x32x16_bf16 v[96:111], v[52:55], a[52:55], v[96:111]
    s_lshr_b32 s67, s66, 7
    s_add_u32 m0, s74, 65536
    s_mul_i32 s67, s67, s85
    buffer_load_dwordx4 v6, s[32:35], s67 offen offset:0 lds
    v_mfma_f32_32x32x16_bf16 v[112:127], v[52:55], a[180:183], v[112:127]
    buffer_load_dwordx4 v7, s[32:35], s67 offen offset:1024 lds
    s_waitcnt lgkmcnt(0)
    v_mfma_f32_32x32x16_bf16 v[64:79], v[40:43], a[56:59], v[64:79]
    ds_read_b64_tr_b16 v[48:49], v22 offset:12288
    ds_read_b64_tr_b16 v[50:51], v22 offset:13312
    ds_read_b128 a[60:63], v17 offset:0
    ds_read_b64_tr_b16 v[52:53], v23 offset:12288
    v_mfma_f32_32x32x16_bf16 v[80:95], v[40:43], a[184:187], v[80:95]
    ds_read_b64_tr_b16 v[54:55], v23 offset:13312
    ds_read_b128 a[188:191], v17 offset:4096
    v_mfma_f32_32x32x16_bf16 v[96:111], v[44:47], a[56:59], v[96:111]
    buffer_load_dwordx4 v8, s[32:35], s67 offen offset:2048 lds
    v_mfma_f32_32x32x16_bf16 v[112:127], v[44:47], a[184:187], v[112:127]
    buffer_load_dwordx4 v9, s[32:35], s67 offen offset:3072 lds
    s_waitcnt lgkmcnt(0)
    s_waitcnt vmcnt(8)
    s_barrier
    s_and_b32 s69, s2, 7
    s_cmp_eq_u32 s69, 0
    s_cbranch_scc1 LQ_nomt28
    s_sub_u32 s69, s69, 1
    s_lshl_b32 s69, s69, 4
    s_lshr_b32 s70, s2, 3
    s_and_b32 s70, s70, 15
    s_add_u32 s69, s69, s70
    s_lshl_b32 s69, s69, 2
    s_add_u32 s69, s69, s56
    s_mul_i32 s70, s69, 3200
    s_mul_i32 s69, s69, 1280
    v_lshl_add_u32 v58, v1, 7, s70
    v_lshl_add_u32 v59, v1, 7, s69
    s_mov_b64 exec, 0x1ffffff
    buffer_load_dword v0, v58, s[40:43], 0 offen
    s_mov_b64 exec, 0x3ff
    buffer_load_dword v0, v59, s[44:47], 0 offen
    s_mov_b64 exec, -1
LQ_nomt28:
    v_mov_b32 v56, 0
    global_load_dword v36, v56, s[22:23] sc1
    v_mfma_f32_32x32x16_bf16 v[64:79], v[48:51], a[60:63], v[64:79]
    ds_read_b64_tr_b16 v[40:41], v22 offset:32768
    ds_read_b64_tr_b16 v[42:43], v22 offset:33792
    ds_read_b128 a[64:67], v14 offset:32768
    ds_read_b64_tr_b16 v[44:45], v23 offset:32768
    v_mfma_f32_32x32x16_bf16 v[80:95], v[48:51], a[188:191], v[80:95]
    ds_read_b64_tr_b16 v[46:47], v23 offset:33792
    ds_read_b128 a[192:195], v14 offset:36864
    v_mfma_f32_32x32x16_bf16 v[96:111], v[52:55], a[60:63], v[96:111]
    s_add_u32 m0, s73, 0
    s_add_u32 s66, s59, 6
    s_and_b32 s66, s66, 7
    s_lshl_b32 s66, s66, 7
    buffer_load_dwordx4 v2, s[28:31], s66 offen offset:0 lds
    v_mfma_f32_32x32x16_bf16 v[112:127], v[52:55], a[188:191], v[112:127]
    buffer_load_dwordx4 v3, s[28:31], s66 offen offset:1024 lds
    s_waitcnt lgkmcnt(0)
    v_mfma_f32_32x32x16_bf16 v[64:79], v[40:43], a[64:67], v[64:79]
    ds_read_b64_tr_b16 v[48:49], v22 offset:36864
    ds_read_b64_tr_b16 v[50:51], v22 offset:37888
    ds_read_b128 a[68:71], v15 offset:32768
    ds_read_b64_tr_b16 v[52:53], v23 offset:36864
    v_mfma_f32_32x32x16_bf16 v[80:95], v[40:43], a[192:195], v[80:95]
    ds_read_b64_tr_b16 v[54:55], v23 offset:37888
    ds_read_b128 a[196:199], v15 offset:36864
    v_mfma_f32_32x32x16_bf16 v[96:111], v[44:47], a[64:67], v[96:111]
    buffer_load_dwordx4 v4, s[28:31], s66 offen offset:2048 lds
    v_mfma_f32_32x32x16_bf16 v[112:127], v[44:47], a[192:195], v[112:127]
    buffer_load_dwordx4 v5, s[28:31], s66 offen offset:3072 lds
    s_waitcnt lgkmcnt(0)
    v_mfma_f32_32x32x16_bf16 v[64:79], v[48:51], a[68:71], v[64:79]
    ds_read_b64_tr_b16 v[40:41], v22 offset:40960
    ds_read_b64_tr_b16 v[42:43], v22 offset:41984
    ds_read_b128 a[72:75], v16 offset:32768
    ds_read_b64_tr_b16 v[44:45], v23 offset:40960
    v_mfma_f32_32x32x16_bf16 v[80:95], v[48:51], a[196:199], v[80:95]
    ds_read_b64_tr_b16 v[46:47], v23 offset:41984
    ds_read_b128 a[200:203], v16 offset:36864
    v_mfma_f32_32x32x16_bf16 v[96:111], v[52:55], a[68:71], v[96:111]
    s_lshr_b32 s67, s66, 7
    s_add_u32 m0, s74, 0
    s_mul_i32 s67, s67, s85
    buffer_load_dwordx4 v6, s[32:35], s67 offen offset:0 lds
    v_mfma_f32_32x32x16_bf16 v[112:127], v[52:55], a[196:199], v[112:127]
    buffer_load_dwordx4 v7, s[32:35], s67 offen offset:1024 lds
    s_waitcnt lgkmcnt(0)
    v_mfma_f32_32x32x16_bf16 v[64:79], v[40:43], a[72:75], v[64:79]
    ds_read_b64_tr_b16 v[48:49], v22 offset:45056
    ds_read_b64_tr_b16 v[50:51], v22 offset:46080
    ds_read_b128 a[76:79], v17 offset:32768
    ds_read_b64_tr_b16 v[52:53], v23 offset:45056
    v_mfma_f32_32x32x16_bf16 v[80:95], v[40:43], a[200:203], v[80:95]
    ds_read_b64_tr_b16 v[54:55], v23 offset:46080
    ds_read_b128 a[204:207], v17 offset:36864
    v_mfma_f32_32x32x16_bf16 v[96:111], v[44:47], a[72:75], v[96:111]
    buffer_load_dwordx4 v8, s[32:35], s67 offen offset:2048 lds
    v_mfma_f32_32x32x16_bf16 v[112:127], v[44:47], a[200:203], v[112:127]
    buffer_load_dwordx4 v9, s[32:35], s67 offen offset:3072 lds
    s_waitcnt lgkmcnt(0)
    s_waitcnt vmcnt(9)
    s_barrier
    v_mfma_f32_32x32x16_bf16 v[64:79], v[48:51], a[76:79], v[64:79]
    ds_read_b64_tr_b16 v[40:41], v24 offset:0
    ds_read_b64_tr_b16 v[42:43], v24 offset:1024
    ds_read_b128 a[80:83], v18 offset:0
    ds_read_b64_tr_b16 v[44:45], v25 offset:0
    v_mfma_f32_32x32x16_bf16 v[80:95], v[48:51], a[204:207], v[80:95]
    ds_read_b64_tr_b16 v[46:47], v25 offset:1024
    ds_read_b128 a[208:211], v18 offset:4096
    v_mfma_f32_32x32x16_bf16 v[96:111], v[52:55], a[76:79], v[96:111]
    s_add_u32 m0, s73, 32768
    s_add_u32 s66, s59, 7
    s_and_b32 s66, s66, 7
    s_lshl_b32 s66, s66, 7
    buffer_load_dwordx4 v2, s[28:31], s66 offen offset:0 lds
    v_mfma_f32_32x32x16_bf16 v[112:127], v[52:55], a[204:207], v[112:127]
    buffer_load_dwordx4 v3, s[28:31], s66 offen offset:1024 lds
    s_waitcnt lgkmcnt(0)
    v_mfma_f32_32x32x16_bf16 v[64:79], v[40:43], a[80:83], v[64:79]
    ds_read_b64_tr_b16 v[48:49], v24 offset:4096
    ds_read_b64_tr_b16 v[50:51], v24 offset:5120
    ds_read_b128 a[84:87], v19 offset:0
    ds_read_b64_tr_b16 v[52:53], v25 offset:4096
    v_mfma_f32_32x32x16_bf16 v[80:95], v[40:43], a[208:211], v[80:95]
    ds_read_b64_tr_b16 v[54:55], v25 offset:5120
    ds_read_b128 a[212:215], v19 offset:4096
    v_mfma_f32_32x32x16_bf16 v[96:111], v[44:47], a[80:83], v[96:111]
    buffer_load_dwordx4 v4, s[28:31], s66 offen offset:2048 lds
    v_mfma_f32_32x32x16_bf16 v[112:127], v[44:47], a[208:211], v[112:127]
    buffer_load_dwordx4 v5, s[28:31], s66 offen offset:3072 lds
    s_waitcnt lgkmcnt(0)
    v_mfma_f32_32x32x16_bf16 v[64:79], v[48:51], a[84:87], v[64:79]
    ds_read_b64_tr_b16 v[40:41], v24 offset:8192
    ds_read_b64_tr_b16 v[42:43], v24 offset:9216
    ds_read_b128 a[88:91], v20 offset:0
    ds_read_b64_tr_b16 v[44:45], v25 offset:8192
    v_mfma_f32_32x32x16_bf16 v[80:95], v[48:51], a[212:215], v[80:95]
    ds_read_b64_tr_b16 v[46:47], v25 offset:9216
    ds_read_b128 a[216:219], v20 offset:4096
    v_mfma_f32_32x32x16_bf16 v[96:111], v[52:55], a[84:87], v[96:111]
    s_lshr_b32 s67, s66, 7
    s_add_u32 m0, s74, 32768
    s_mul_i32 s67, s67, s85
    buffer_load_dwordx4 v6, s[32:35], s67 offen offset:0 lds
    v_mfma_f32_32x32x16_bf16 v[112:127], v[52:55], a[212:215], v[112:127]
    buffer_load_dwordx4 v7, s[32:35], s67 offen offset:1024 lds
    s_waitcnt lgkmcnt(0)
    v_mfma_f32_32x32x16_bf16 v[64:79], v[40:43], a[88:91], v[64:79]
    ds_read_b64_tr_b16 v[48:49], v24 offset:12288
    ds_read_b64_tr_b16 v[50:51], v24 offset:13312
    ds_read_b128 a[92:95], v21 offset:0
    ds_read_b64_tr_b16 v[52:53], v25 offset:12288
    v_mfma_f32_32x32x16_bf16 v[80:95], v[40:43], a[216:219], v[80:95]
    ds_read_b64_tr_b16 v[54:55], v25 offset:13312
    ds_read_b128 a[220:223], v21 offset:4096
    v_mfma_f32_32x32x16_bf16 v[96:111], v[44:47], a[88:91], v[96:111]
    buffer_load_dwordx4 v8, s[32:35], s67 offen offset:2048 lds
    v_mfma_f32_32x32x16_bf16 v[112:127], v[44:47], a[216:219], v[112:127]
    buffer_load_dwordx4 v9, s[32:35], s67 offen offset:3072 lds
    s_waitcnt vmcnt(16)
    v_readfirstlane_b32 s64, v36
    s_nop 3
    s_cmp_lg_u32 s64, 0
    s_cbranch_scc0 LQ_nd31_ool1
LQ_nd31:
LQ_nz229:
    s_waitcnt lgkmcnt(0)
    s_waitcnt vmcnt(8)
    s_barrier
    v_mfma_f32_32x32x16_bf16 v[64:79], v[48:51], a[92:95], v[64:79]
    ds_read_b64_tr_b16 v[40:41], v22 offset:0
    ds_read_b64_tr_b16 v[42:43], v22 offset:1024
    ds_read_b128 a[96:99], v14 offset:0
    ds_read_b64_tr_b16 v[44:45], v23 offset:0
    v_mfma_f32_32x32x16_bf16 v[80:95], v[48:51], a[220:223], v[80:95]
    ds_read_b64_tr_b16 v[46:47], v23 offset:1024
    ds_read_b128 a[224:227], v14 offset:4096
    v_mfma_f32_32x32x16_bf16 v[96:111], v[52:55], a[92:95], v[96:111]
    s_add_u32 m0, s75, 0
    s_add_u32 s68, s59, 0
    s_and_b32 s68, s68, 7
    s_mul_i32 s67, s68, 196608
    buffer_load_dwordx4 v10, s[36:39], s67 offen offset:0 lds
    v_mfma_f32_32x32x16_bf16 v[112:127], v[52:55], a[220:223], v[112:127]
    buffer_load_dwordx4 v11, s[36:39], s67 offen offset:1024 lds
    s_waitcnt lgkmcnt(0)
    v_mfma_f32_32x32x16_bf16 v[64:79], v[40:43], a[96:99], v[64:79]
    ds_read_b64_tr_b16 v[48:49], v22 offset:4096
    ds_read_b64_tr_b16 v[50:51], v22 offset:5120
    ds_read_b128 a[100:103], v15 offset:0
    ds_read_b64_tr_b16 v[52:53], v23 offset:4096
    v_mfma_f32_32x32x16_bf16 v[80:95], v[40:43], a[224:227], v[80:95]
    ds_read_b64_tr_b16 v[54:55], v23 offset:5120
    ds_read_b128 a[228:231], v15 offset:4096
    v_mfma_f32_32x32x16_bf16 v[96:111], v[44:47], a[96:99], v[96:111]
    s_add_u32 m0, s75, 8192
    s_add_u32 s68, s59, 1
    s_and_b32 s68, s68, 7
    s_mul_i32 s67, s68, 196608
    buffer_load_dwordx4 v10, s[36:39], s67 offen offset:0 lds
    v_mfma_f32_32x32x16_bf16 v[112:127], v[44:47], a[224:227], v[112:127]
    buffer_load_dwordx4 v11, s[36:39], s67 offen offset:1024 lds
    s_waitcnt lgkmcnt(0)
    v_mfma_f32_32x32x16_bf16 v[64:79], v[48:51], a[100:103], v[64:79]
    ds_read_b64_tr_b16 v[40:41], v22 offset:8192
    ds_read_b64_tr_b16 v[42:43], v22 offset:9216
    ds_read_b128 a[104:107], v16 offset:0
    ds_read_b64_tr_b16 v[44:45], v23 offset:8192
    v_mfma_f32_32x32x16_bf16 v[80:95], v[48:51], a[228:231], v[80:95]
    ds_read_b64_tr_b16 v[46:47], v23 offset:9216
    ds_read_b128 a[232:235], v16 offset:4096
    v_mfma_f32_32x32x16_bf16 v[96:111], v[52:55], a[100:103], v[96:111]
    s_add_u32 m0, s75, 16384
    s_add_u32 s68, s59, 2
    s_and_b32 s68, s68, 7
    s_mul_i32 s67, s68, 196608
    buffer_load_dwordx4 v10, s[36:39], s67 offen offset:0 lds
    v_mfma_f32_32x32x16_bf16 v[112:127], v[52:55], a[228:231], v[112:127]
    buffer_load_dwordx4 v11, s[36:39], s67 offen offset:1024 lds
    s_waitcnt lgkmcnt(0)
    v_mfma_f32_32x32x16_bf16 v[64:79], v[40:43], a[104:107], v[64:79]
    ds_read_b64_tr_b16 v[48:49], v22 offset:12288
    ds_read_b64_tr_b16 v[50:51], v22 offset:13312
    ds_read_b128 a[108:111], v17 offset:0
    ds_read_b64_tr_b16 v[52:53], v23 offset:12288
    v_mfma_f32_32x32x16_bf16 v[80:95], v[40:43], a[232:235], v[80:95]
    ds_read_b64_tr_b16 v[54:55], v23 offset:13312
    ds_read_b128 a[236:239], v17 offset:4096
    v_mfma_f32_32x32x16_bf16 v[96:111], v[44:47], a[104:107], v[96:111]
    s_add_u32 m0, s75, 24576
    s_add_u32 s68, s59, 3
    s_and_b32 s68, s68, 7
    s_mul_i32 s67, s68, 196608
    buffer_load_dwordx4 v10, s[36:39], s67 offen offset:0 lds
    v_mfma_f32_32x32x16_bf16 v[112:127], v[44:47], a[232:235], v[112:127]
    buffer_load_dwordx4 v11, s[36:39], s67 offen offset:1024 lds
    s_waitcnt lgkmcnt(0)
    s_waitcnt vmcnt(8)
    s_barrier
    v_mfma_f32_32x32x16_bf16 v[64:79], v[48:51], a[108:111], v[64:79]
    ds_read_b64_tr_b16 v[40:41], v22 offset:32768
    ds_read_b64_tr_b16 v[42:43], v22 offset:33792
    ds_read_b128 a[112:115], v14 offset:32768
    ds_read_b64_tr_b16 v[44:45], v23 offset:32768
    v_mfma_f32_32x32x16_bf16 v[80:95], v[48:51], a[236:239], v[80:95]
    ds_read_b64_tr_b16 v[46:47], v23 offset:33792
    ds_read_b128 a[240:243], v14 offset:36864
    v_mfma_f32_32x32x16_bf16 v[96:111], v[52:55], a[108:111], v[96:111]
    s_add_u32 m0, s75, 32768
    s_add_u32 s68, s59, 4
    s_and_b32 s68, s68, 7
    s_mul_i32 s67, s68, 196608
    buffer_load_dwordx4 v10, s[36:39], s67 offen offset:0 lds
    v_mfma_f32_32x32x16_bf16 v[112:127], v[52:55], a[236:239], v[112:127]
    buffer_load_dwordx4 v11, s[36:39], s67 offen offset:1024 lds
    s_waitcnt lgkmcnt(0)
    v_mfma_f32_32x32x16_bf16 v[64:79], v[40:43], a[112:115], v[64:79]
    ds_read_b64_tr_b16 v[48:49], v22 offset:36864
    ds_read_b64_tr_b16 v[50:51], v22 offset:37888
    ds_read_b128 a[116:119], v15 offset:32768
    ds_read_b64_tr_b16 v[52:53], v23 offset:36864
    v_mfma_f32_32x32x16_bf16 v[80:95], v[40:43], a[240:243], v[80:95]
    ds_read_b64_tr_b16 v[54:55], v23 offset:37888
    ds_read_b128 a[244:247], v15 offset:36864
    v_mfma_f32_32x32x16_bf16 v[96:111], v[44:47], a[112:115], v[96:111]
    s_add_u32 m0, s75, 40960
    s_add_u32 s68, s59, 5
    s_and_b32 s68, s68, 7
    s_mul_i32 s67, s68, 196608
    buffer_load_dwordx4 v10, s[36:39], s67 offen offset:0 lds
    v_mfma_f32_32x32x16_bf16 v[112:127], v[44:47], a[240:243], v[112:127]
    buffer_load_dwordx4 v11, s[36:39], s67 offen offset:1024 lds
    s_waitcnt lgkmcnt(0)
    v_mfma_f32_32x32x16_bf16 v[64:79], v[48:51], a[116:119], v[64:79]
    ds_read_b64_tr_b16 v[40:41], v22 offset:40960
    ds_read_b64_tr_b16 v[42:43], v22 offset:41984
    ds_read_b128 a[120:123], v16 offset:32768
    ds_read_b64_tr_b16 v[44:45], v23 offset:40960
    v_mfma_f32_32x32x16_bf16 v[80:95], v[48:51], a[244:247], v[80:95]
    ds_read_b64_tr_b16 v[46:47], v23 offset:41984
    ds_read_b128 a[248:251], v16 offset:36864
    v_mfma_f32_32x32x16_bf16 v[96:111], v[52:55], a[116:119], v[96:111]
    s_add_u32 m0, s75, 49152
    s_add_u32 s68, s59, 6
    s_and_b32 s68, s68, 7
    s_mul_i32 s67, s68, 196608
    buffer_load_dwordx4 v10, s[36:39], s67 offen offset:0 lds
    v_mfma_f32_32x32x16_bf16 v[112:127], v[52:55], a[244:247], v[112:127]
    buffer_load_dwordx4 v11, s[36:39], s67 offen offset:1024 lds
    s_waitcnt lgkmcnt(0)
    v_mfma_f32_32x32x16_bf16 v[64:79], v[40:43], a[120:123], v[64:79]
    ds_read_b64_tr_b16 v[48:49], v22 offset:45056
    ds_read_b64_tr_b16 v[50:51], v22 offset:46080
    ds_read_b128 a[124:127], v17 offset:32768
    ds_read_b64_tr_b16 v[52:53], v23 offset:45056
    v_mfma_f32_32x32x16_bf16 v[80:95], v[40:43], a[248:251], v[80:95]
    ds_read_b64_tr_b16 v[54:55], v23 offset:46080
    ds_read_b128 a[252:255], v17 offset:36864
    v_mfma_f32_32x32x16_bf16 v[96:111], v[44:47], a[120:123], v[96:111]
    s_add_u32 m0, s75, 57344
    s_add_u32 s68, s59, 7
    s_and_b32 s68, s68, 7
    s_mul_i32 s67, s68, 196608
    buffer_load_dwordx4 v10, s[36:39], s67 offen offset:0 lds
    v_mfma_f32_32x32x16_bf16 v[112:127], v[44:47], a[248:251], v[112:127]
    buffer_load_dwordx4 v11, s[36:39], s67 offen offset:1024 lds
    s_waitcnt lgkmcnt(0)
    s_waitcnt vmcnt(8)
    s_barrier
    v_mfma_f32_32x32x16_bf16 v[64:79], v[48:51], a[124:127], v[64:79]
    v_mfma_f32_32x32x16_bf16 v[80:95], v[48:51], a[252:255], v[80:95]
    v_mfma_f32_32x32x16_bf16 v[96:111], v[52:55], a[124:127], v[96:111]
    v_mfma_f32_32x32x16_bf16 v[112:127], v[52:55], a[252:255], v[112:127]
    s_lshl_b32 s83, s58, 2
    s_add_u32 s83, s83, s61
    s_lshl_b32 s83, s83, 11
    s_add_u32 s84, s83, 4096
    ds_read_b64_tr_b16 v[40:41], v26 offset:0
    ds_read_b64_tr_b16 v[42:43], v26 offset:512
    ds_read_b64_tr_b16 v[48:49], v26 offset:2048
    ds_read_b64_tr_b16 v[50:51], v26 offset:2560
    s_waitcnt lgkmcnt(2)
    v_mfma_f32_32x32x16_bf16 v[128:143], v[40:43], a[0:3], 0
    v_cvt_pk_bf16_f32 v64, v64, v65
    v_cvt_pk_bf16_f32 v65, v66, v67
    v_cvt_pk_bf16_f32 v66, v68, v69
    v_cvt_pk_bf16_f32 v67, v70, v71
    v_cvt_pk_bf16_f32 v68, v72, v73
    v_cvt_pk_bf16_f32 v69, v74, v75
    v_cvt_pk_bf16_f32 v70, v76, v77
    v_cvt_pk_bf16_f32 v71, v78, v79
    v_mfma_f32_32x32x16_bf16 v[144:159], v[40:43], a[128:131], 0
    v_pk_max_i16 v64, v64, 0
    v_pk_max_i16 v65, v65, 0
    v_pk_max_i16 v66, v66, 0
    v_pk_max_i16 v67, v67, 0
    v_pk_max_i16 v68, v68, 0
    v_pk_max_i16 v69, v69, 0
    v_pk_max_i16 v70, v70, 0
    ds_read_b64_tr_b16 v[40:41], v26 offset:4096
    ds_read_b64_tr_b16 v[42:43], v26 offset:4608
    s_waitcnt lgkmcnt(2)
    v_mfma_f32_32x32x16_bf16 v[128:143], v[48:51], a[4:7], v[128:143]
    v_pk_max_i16 v71, v71, 0
    buffer_store_dwordx4 v[64:67], v33, s[48:51], s83 offen sc1
    buffer_store_dwordx4 v[68:71], v33, s[48:51], s83 offen offset:1024 sc1
    v_cvt_pk_bf16_f32 v80, v80, v81
    v_cvt_pk_bf16_f32 v81, v82, v83
    v_cvt_pk_bf16_f32 v82, v84, v85
    v_cvt_pk_bf16_f32 v83, v86, v87
    v_mfma_f32_32x32x16_bf16 v[144:159], v[48:51], a[132:135], v[144:159]
    v_cvt_pk_bf16_f32 v84, v88, v89
    v_cvt_pk_bf16_f32 v85, v90, v91
    v_cvt_pk_bf16_f32 v86, v92, v93
    v_cvt_pk_bf16_f32 v87, v94, v95
    v_pk_max_i16 v80, v80, 0
    v_pk_max_i16 v81, v81, 0
    v_pk_max_i16 v82, v82, 0
    ds_read_b64_tr_b16 v[48:49], v26 offset:6144
    ds_read_b64_tr_b16 v[50:51], v26 offset:6656
    s_waitcnt lgkmcnt(2)
    v_mfma_f32_32x32x16_bf16 v[128:143], v[40:43], a[8:11], v[128:143]
    v_pk_max_i16 v83, v83, 0
    v_pk_max_i16 v84, v84, 0
    v_pk_max_i16 v85, v85, 0
    v_pk_max_i16 v86, v86, 0
    v_pk_max_i16 v87, v87, 0
    buffer_store_dwordx4 v[80:83], v34, s[48:51], s83 offen sc1
    buffer_store_dwordx4 v[84:87], v34, s[48:51], s83 offen offset:1024 sc1
    v_mfma_f32_32x32x16_bf16 v[144:159], v[40:43], a[136:139], v[144:159]
    v_cvt_pk_bf16_f32 v96, v96, v97
    v_cvt_pk_bf16_f32 v97, v98, v99
    v_cvt_pk_bf16_f32 v98, v100, v101
    v_cvt_pk_bf16_f32 v99, v102, v103
    v_cvt_pk_bf16_f32 v100, v104, v105
    v_cvt_pk_bf16_f32 v101, v106, v107
    v_cvt_pk_bf16_f32 v102, v108, v109
    v_cvt_pk_bf16_f32 v103, v110, v111
    ds_read_b64_tr_b16 v[40:41], v26 offset:8192
    ds_read_b64_tr_b16 v[42:43], v26 offset:8704
    s_waitcnt lgkmcnt(2)
    v_mfma_f32_32x32x16_bf16 v[128:143], v[48:51], a[12:15], v[128:143]
    v_pk_max_i16 v96, v96, 0
    v_pk_max_i16 v97, v97, 0
    v_pk_max_i16 v98, v98, 0
    v_pk_max_i16 v99, v99, 0
    v_pk_max_i16 v100, v100, 0
    v_pk_max_i16 v101, v101, 0
    v_pk_max_i16 v102, v102, 0
    v_mfma_f32_32x32x16_bf16 v[144:159], v[48:51], a[140:143], v[144:159]
    v_pk_max_i16 v103, v103, 0
    buffer_store_dwordx4 v[96:99], v33, s[48:51], s84 offen sc1
    buffer_store_dwordx4 v[100:103], v33, s[48:51], s84 offen offset:1024 sc1
    v_cvt_pk_bf16_f32 v112, v112, v113
    v_cvt_pk_bf16_f32 v113, v114, v115
    v_cvt_pk_bf16_f32 v114, v116, v117
    v_cvt_pk_bf16_f32 v115, v118, v119
    ds_read_b64_tr_b16 v[48:49], v26 offset:10240
    ds_read_b64_tr_b16 v[50:51], v26 offset:10752
    s_waitcnt lgkmcnt(2)
    v_mfma_f32_32x32x16_bf16 v[128:143], v[40:43], a[16:19], v[128:143]
    v_cvt_pk_bf16_f32 v116, v120, v121
    v_cvt_pk_bf16_f32 v117, v122, v123
    v_cvt_pk_bf16_f32 v118, v124, v125
    v_cvt_pk_bf16_f32 v119, v126, v127
    v_pk_max_i16 v112, v112, 0
    v_pk_max_i16 v113, v113, 0
    v_pk_max_i16 v114, v114, 0
    v_mfma_f32_32x32x16_bf16 v[144:159], v[40:43], a[144:147], v[144:159]
    v_pk_max_i16 v115, v115, 0
    v_pk_max_i16 v116, v116, 0
    v_pk_max_i16 v117, v117, 0
    v_pk_max_i16 v118, v118, 0
    v_pk_max_i16 v119, v119, 0
    buffer_store_dwordx4 v[112:115], v34, s[48:51], s84 offen sc1
    buffer_store_dwordx4 v[116:119], v34, s[48:51], s84 offen offset:1024 sc1
    ds_read_b64_tr_b16 v[40:41], v26 offset:12288
    ds_read_b64_tr_b16 v[42:43], v26 offset:12800
    s_waitcnt lgkmcnt(2)
    v_mfma_f32_32x32x16_bf16 v[128:143], v[48:51], a[20:23], v[128:143]
    v_mfma_f32_32x32x16_bf16 v[144:159], v[48:51], a[148:151], v[144:159]
    ds_read_b64_tr_b16 v[48:49], v26 offset:14336
    ds_read_b64_tr_b16 v[50:51], v26 offset:14848
    s_waitcnt lgkmcnt(2)
    v_mfma_f32_32x32x16_bf16 v[128:143], v[40:43], a[24:27], v[128:143]
    v_mfma_f32_32x32x16_bf16 v[144:159], v[40:43], a[152:155], v[144:159]
    ds_read_b64_tr_b16 v[40:41], v26 offset:16384
    ds_read_b64_tr_b16 v[42:43], v26 offset:16896
    s_waitcnt lgkmcnt(2)
    v_mfma_f32_32x32x16_bf16 v[128:143], v[48:51], a[28:31], v[128:143]
    v_mfma_f32_32x32x16_bf16 v[144:159], v[48:51], a[156:159], v[144:159]
    ds_read_b64_tr_b16 v[48:49], v26 offset:18432
    ds_read_b64_tr_b16 v[50:51], v26 offset:18944
    s_waitcnt lgkmcnt(2)
    v_mfma_f32_32x32x16_bf16 v[128:143], v[40:43], a[32:35], v[128:143]
    v_mfma_f32_32x32x16_bf16 v[144:159], v[40:43], a[160:163], v[144:159]
    ds_read_b64_tr_b16 v[40:41], v26 offset:20480
    ds_read_b64_tr_b16 v[42:43], v26 offset:20992
    s_waitcnt lgkmcnt(2)
    v_mfma_f32_32x32x16_bf16 v[128:143], v[48:51], a[36:39], v[128:143]
    v_mfma_f32_32x32x16_bf16 v[144:159], v[48:51], a[164:167], v[144:159]
    ds_read_b64_tr_b16 v[48:49], v26 offset:22528
    ds_read_b64_tr_b16 v[50:51], v26 offset:23040
    s_waitcnt lgkmcnt(2)
    v_mfma_f32_32x32x16_bf16 v[128:143], v[40:43], a[40:43], v[128:143]
    v_mfma_f32_32x32x16_bf16 v[144:159], v[40:43], a[168:171], v[144:159]
    ds_read_b64_tr_b16 v[40:41], v26 offset:24576
    ds_read_b64_tr_b16 v[42:43], v26 offset:25088
    s_waitcnt lgkmcnt(2)
    v_mfma_f32_32x32x16_bf16 v[128:143], v[48:51], a[44:47], v[128:143]
    v_mfma_f32_32x32x16_bf16 v[144:159], v[48:51], a[172:175], v[144:159]
    ds_read_b64_tr_b16 v[48:49], v26 offset:26624
    ds_read_b64_tr_b16 v[50:51], v26 offset:27136
    s_waitcnt lgkmcnt(2)
    v_mfma_f32_32x32x16_bf16 v[128:143], v[40:43], a[48:51], v[128:143]
    v_mfma_f32_32x32x16_bf16 v[144:159], v[40:43], a[176:179], v[144:159]
    ds_read_b64_tr_b16 v[40:41], v26 offset:28672
    ds_read_b64_tr_b16 v[42:43], v26 offset:29184
    s_waitcnt lgkmcnt(2)
    v_mfma_f32_32x32x16_bf16 v[128:143], v[48:51], a[52:55], v[128:143]
    v_mfma_f32_32x32x16_bf16 v[144:159], v[48:51], a[180:183], v[144:159]
    ds_read_b64_tr_b16 v[48:49], v26 offset:30720
    ds_read_b64_tr_b16 v[50:51], v26 offset:31232
    s_waitcnt lgkmcnt(2)
    v_mfma_f32_32x32x16_bf16 v[128:143], v[40:43], a[56:59], v[128:143]
    v_mfma_f32_32x32x16_bf16 v[144:159], v[40:43], a[184:187], v[144:159]
    s_waitcnt lgkmcnt(0)
    s_waitcnt vmcnt(8)
    s_barrier
    ds_read_b64_tr_b16 v[40:41], v26 offset:32768
    ds_read_b64_tr_b16 v[42:43], v26 offset:33280
    s_waitcnt lgkmcnt(2)
    v_mfma_f32_32x32x16_bf16 v[128:143], v[48:51], a[60:63], v[128:143]
    v_mfma_f32_32x32x16_bf16 v[144:159], v[48:51], a[188:191], v[144:159]
    ds_read_b64_tr_b16 v[48:49], v26 offset:34816
    ds_read_b64_tr_b16 v[50:51], v26 offset:35328
    s_waitcnt lgkmcnt(2)
    v_mfma_f32_32x32x16_bf16 v[128:143], v[40:43], a[64:67], v[128:143]
    v_mfma_f32_32x32x16_bf16 v[144:159], v[40:43], a[192:195], v[144:159]
    ds_read_b64_tr_b16 v[40:41], v26 offset:36864
    ds_read_b64_tr_b16 v[42:43], v26 offset:37376
    s_waitcnt lgkmcnt(2)
    v_mfma_f32_32x32x16_bf16 v[128:143], v[48:51], a[68:71], v[128:143]
    v_mfma_f32_32x32x16_bf16 v[144:159], v[48:51], a[196:199], v[144:159]
    ds_read_b64_tr_b16 v[48:49], v26 offset:38912
    ds_read_b64_tr_b16 v[50:51], v26 offset:39424
    s_waitcnt lgkmcnt(2)
    v_mfma_f32_32x32x16_bf16 v[128:143], v[40:43], a[72:75], v[128:143]
    v_mfma_f32_32x32x16_bf16 v[144:159], v[40:43], a[200:203], v[144:159]
    ds_read_b64_tr_b16 v[40:41], v26 offset:40960
    ds_read_b64_tr_b16 v[42:43], v26 offset:41472
    s_waitcnt lgkmcnt(2)
    v_mfma_f32_32x32x16_bf16 v[128:143], v[48:51], a[76:79], v[128:143]
    s_add_u32 m0, s76, 0
    s_nop 0
    buffer_load_dwordx4 v12, s[40:43], s81 offen lds
    buffer_load_dwordx4 v13, s[40:43], s81 offen offset:1024 lds
    v_mfma_f32_32x32x16_bf16 v[144:159], v[48:51], a[204:207], v[144:159]
    ds_read_b64_tr_b16 v[48:49], v26 offset:43008
    ds_read_b64_tr_b16 v[50:51], v26 offset:43520
    s_waitcnt lgkmcnt(2)
    v_mfma_f32_32x32x16_bf16 v[128:143], v[40:43], a[80:83], v[128:143]
    s_add_u32 m0, s76, 2048
    s_add_u32 s81, s81, 16384
    s_and_b32 s81, s81, 262143
    buffer_load_dwordx4 v12, s[40:43], s81 offen lds
    buffer_load_dwordx4 v13, s[40:43], s81 offen offset:1024 lds
    v_mfma_f32_32x32x16_bf16 v[144:159], v[40:43], a[208:211], v[144:159]
    ds_read_b64_tr_b16 v[40:41], v26 offset:45056
    ds_read_b64_tr_b16 v[42:43], v26 offset:45568
    s_waitcnt lgkmcnt(2)
    v_mfma_f32_32x32x16_bf16 v[128:143], v[48:51], a[84:87], v[128:143]
    s_add_u32 m0, s76, 4096
    s_add_u32 s81, s81, 16384
    s_and_b32 s81, s81, 262143
    buffer_load_dwordx4 v12, s[40:43], s81 offen lds
    buffer_load_dwordx4 v13, s[40:43], s81 offen offset:1024 lds
    v_mfma_f32_32x32x16_bf16 v[144:159], v[48:51], a[212:215], v[144:159]
    ds_read_b64_tr_b16 v[48:49], v26 offset:47104
    ds_read_b64_tr_b16 v[50:51], v26 offset:47616
    s_waitcnt lgkmcnt(2)
    v_mfma_f32_32x32x16_bf16 v[128:143], v[40:43], a[88:91], v[128:143]
    s_add_u32 m0, s76, 6144
    s_add_u32 s81, s81, 16384
    s_and_b32 s81, s81, 262143
    buffer_load_dwordx4 v12, s[40:43], s81 offen lds
    buffer_load_dwordx4 v13, s[40:43], s81 offen offset:1024 lds
    v_mfma_f32_32x32x16_bf16 v[144:159], v[40:43], a[216:219], v[144:159]
    ds_read_b64_tr_b16 v[40:41], v26 offset:49152
    ds_read_b64_tr_b16 v[42:43], v26 offset:49664
    s_waitcnt lgkmcnt(2)
    v_mfma_f32_32x32x16_bf16 v[128:143], v[48:51], a[92:95], v[128:143]
    s_add_u32 m0, s76, 8192
    s_add_u32 s81, s81, 16384
    s_and_b32 s81, s81, 262143
    buffer_load_dwordx4 v12, s[40:43], s81 offen lds
    buffer_load_dwordx4 v13, s[40:43], s81 offen offset:1024 lds
    v_mfma_f32_32x32x16_bf16 v[144:159], v[48:51], a[220:223], v[144:159]
    ds_read_b64_tr_b16 v[48:49], v26 offset:51200
    ds_read_b64_tr_b16 v[50:51], v26 offset:51712
    s_waitcnt lgkmcnt(2)
    v_mfma_f32_32x32x16_bf16 v[128:143], v[40:43], a[96:99], v[128:143]
    s_add_u32 m0, s76, 10240
    s_add_u32 s81, s81, 16384
    s_and_b32 s81, s81, 262143
    buffer_load_dwordx4 v12, s[40:43], s81 offen lds
    buffer_load_dwordx4 v13, s[40:43], s81 offen offset:1024 lds
    v_mfma_f32_32x32x16_bf16 v[144:159], v[40:43], a[224:227], v[144:159]
    ds_read_b64_tr_b16 v[40:41], v26 offset:53248
    ds_read_b64_tr_b16 v[42:43], v26 offset:53760
    s_waitcnt lgkmcnt(2)
    v_mfma_f32_32x32x16_bf16 v[128:143], v[48:51], a[100:103], v[128:143]
    s_add_u32 m0, s76, 12288
    s_add_u32 s81, s81, 16384
    s_and_b32 s81, s81, 262143
    buffer_load_dwordx4 v12, s[40:43], s81 offen lds
    buffer_load_dwordx4 v13, s[40:43], s81 offen offset:1024 lds
    v_mfma_f32_32x32x16_bf16 v[144:159], v[48:51], a[228:231], v[144:159]
    ds_read_b64_tr_b16 v[48:49], v26 offset:55296
    ds_read_b64_tr_b16 v[50:51], v26 offset:55808
    s_waitcnt lgkmcnt(2)
    v_mfma_f32_32x32x16_bf16 v[128:143], v[40:43], a[104:107], v[128:143]
    s_add_u32 m0, s76, 14336
    s_add_u32 s81, s81, 16384
    s_and_b32 s81, s81, 262143
    buffer_load_dwordx4 v12, s[40:43], s81 offen lds
    buffer_load_dwordx4 v13, s[40:43], s81 offen offset:1024 lds
    v_mfma_f32_32x32x16_bf16 v[144:159], v[40:43], a[232:235], v[144:159]
    ds_read_b64_tr_b16 v[40:41], v26 offset:57344
    ds_read_b64_tr_b16 v[42:43], v26 offset:57856
    s_waitcnt lgkmcnt(2)
    v_mfma_f32_32x32x16_bf16 v[128:143], v[48:51], a[108:111], v[128:143]
    s_add_u32 m0, s76, 16384
    s_add_u32 s81, s81, 16384
    s_and_b32 s81, s81, 262143
    buffer_load_dwordx4 v12, s[40:43], s81 offen lds
    buffer_load_dwordx4 v13, s[40:43], s81 offen offset:1024 lds
    v_mfma_f32_32x32x16_bf16 v[144:159], v[48:51], a[236:239], v[144:159]
    ds_read_b64_tr_b16 v[48:49], v26 offset:59392
    ds_read_b64_tr_b16 v[50:51], v26 offset:59904
    s_waitcnt lgkmcnt(2)
    v_mfma_f32_32x32x16_bf16 v[128:143], v[40:43], a[112:115], v[128:143]
    v_mfma_f32_32x32x16_bf16 v[144:159], v[40:43], a[240:243], v[144:159]
    ds_read_b64_tr_b16 v[40:41], v26 offset:61440
    ds_read_b64_tr_b16 v[42:43], v26 offset:61952
    s_waitcnt lgkmcnt(2)
    v_mfma_f32_32x32x16_bf16 v[128:143], v[48:51], a[116:119], v[128:143]
    s_add_u32 m0, s76, 18432
    s_add_u32 s81, s81, 16384
    s_and_b32 s81, s81, 262143
    buffer_load_dwordx4 v12, s[40:43], s81 offen lds
    buffer_load_dwordx4 v13, s[40:43], s81 offen offset:1024 lds
    v_mfma_f32_32x32x16_bf16 v[144:159], v[48:51], a[244:247], v[144:159]
    ds_read_b64_tr_b16 v[48:49], v26 offset:63488
    ds_read_b64_tr_b16 v[50:51], v26 offset:64000
    s_waitcnt lgkmcnt(2)
    v_mfma_f32_32x32x16_bf16 v[128:143], v[40:43], a[120:123], v[128:143]
    v_mfma_f32_32x32x16_bf16 v[144:159], v[40:43], a[248:251], v[144:159]
    s_waitcnt lgkmcnt(0)
    s_barrier
    v_mfma_f32_32x32x16_bf16 v[128:143], v[48:51], a[124:127], v[128:143]
    s_add_u32 m0, s76, 20480
    s_add_u32 s81, s81, 16384
    s_and_b32 s81, s81, 262143
    buffer_load_dwordx4 v12, s[40:43], s81 offen lds
    buffer_load_dwordx4 v13, s[40:43], s81 offen offset:1024 lds
    v_mfma_f32_32x32x16_bf16 v[144:159], v[48:51], a[252:255], v[144:159]
    s_nop 5
    v_cvt_pk_bf16_f32 v224, v128, v129
    v_cvt_pk_bf16_f32 v225, v130, v131
    v_cvt_pk_bf16_f32 v226, v132, v133
    v_cvt_pk_bf16_f32 v227, v134, v135
    s_waitcnt vmcnt(22)
    s_add_u32 s68, s100, 10485760
    v_mov_b32 v62, 0
    v_mov_b32 v63, s64
    s_mov_b64 exec, 1
    buffer_store_dword v63, v62, s[48:51], s68 offen sc1
    s_mov_b64 exec, -1
    v_cvt_pk_bf16_f32 v228, v136, v137
    v_cvt_pk_bf16_f32 v229, v138, v139
    v_cvt_pk_bf16_f32 v230, v140, v141
    v_cvt_pk_bf16_f32 v231, v142, v143
    v_cvt_pk_bf16_f32 v232, v144, v145
    v_cvt_pk_bf16_f32 v233, v146, v147
    v_cvt_pk_bf16_f32 v234, v148, v149
    v_cvt_pk_bf16_f32 v235, v150, v151
    v_cvt_pk_bf16_f32 v236, v152, v153
    v_cvt_pk_bf16_f32 v237, v154, v155
    v_cvt_pk_bf16_f32 v238, v156, v157
    v_cvt_pk_bf16_f32 v239, v158, v159
    v_mfma_f32_32x32x16_bf16 v[160:175], v[240:243], v[224:227], 0
    s_waitcnt vmcnt(21)
    ds_read_b64_tr_b16 a[0:1], v27 offset:0
    ds_read_b64_tr_b16 a[2:3], v27 offset:1024
    ds_read_b64_tr_b16 a[128:129], v28 offset:0
    ds_read_b64_tr_b16 a[130:131], v28 offset:1024
    s_waitcnt vmcnt(19)
    ds_read_b64_tr_b16 a[4:5], v27 offset:2048
    ds_read_b64_tr_b16 a[6:7], v27 offset:3072
    ds_read_b64_tr_b16 a[132:133], v28 offset:2048
    ds_read_b64_tr_b16 a[134:135], v28 offset:3072
    s_waitcnt vmcnt(17)
    ds_read_b64_tr_b16 a[8:9], v27 offset:4096
    ds_read_b64_tr_b16 a[10:11], v27 offset:5120
    ds_read_b64_tr_b16 a[136:137], v28 offset:4096
    ds_read_b64_tr_b16 a[138:139], v28 offset:5120
    v_mfma_f32_32x32x16_bf16 v[176:191], v[244:247], v[228:231], 0
    v_mfma_f32_32x32x16_bf16 v[192:207], v[240:243], v[232:235], 0
    v_mfma_f32_32x32x16_bf16 v[208:223], v[244:247], v[236:239], 0
    v_and_b32 v35, 15, v1
    v_lshlrev_b32 v35, 2, v35
    v_max3_f32 v56, v160, v161, v162
    v_max3_f32 v57, v163, v164, v165
    v_max3_f32 v56, v56, v166, v167
    v_max3_f32 v57, v57, v168, v169
    v_max3_f32 v56, v56, v170, v171
    v_max3_f32 v57, v57, v172, v173
    v_max3_f32 v56, v56, v174, v175
    s_waitcnt lgkmcnt(8)
    s_add_u32 m0, s76, 0
    s_add_u32 s81, s81, 16384
    s_and_b32 s81, s81, 262143
    buffer_load_dwordx4 v12, s[40:43], s81 offen lds
    buffer_load_dwordx4 v13, s[40:43], s81 offen offset:1024 lds
    s_waitcnt vmcnt(17)
    ds_read_b64_tr_b16 a[12:13], v27 offset:6144
    ds_read_b64_tr_b16 a[14:15], v27 offset:7168
    ds_read_b64_tr_b16 a[140:141], v28 offset:6144
    ds_read_b64_tr_b16 a[142:143], v28 offset:7168
    v_max_f32 v56, v56, v57
    v_mul_f32_e64 v56, -v56, s98
    v_pk_fma_f32 v[160:161], v[160:161], s[98:99], v[56:57] op_sel_hi:[1,0,0]
    v_pk_fma_f32 v[162:163], v[162:163], s[98:99], v[56:57] op_sel_hi:[1,0,0]
    v_pk_fma_f32 v[164:165], v[164:165], s[98:99], v[56:57] op_sel_hi:[1,0,0]
    v_pk_fma_f32 v[166:167], v[166:167], s[98:99], v[56:57] op_sel_hi:[1,0,0]
    v_pk_fma_f32 v[168:169], v[168:169], s[98:99], v[56:57] op_sel_hi:[1,0,0]
    v_pk_fma_f32 v[170:171], v[170:171], s[98:99], v[56:57] op_sel_hi:[1,0,0]
    v_pk_fma_f32 v[172:173], v[172:173], s[98:99], v[56:57] op_sel_hi:[1,0,0]
    v_pk_fma_f32 v[174:175], v[174:175], s[98:99], v[56:57] op_sel_hi:[1,0,0]
    v_exp_f32 v160, v160
    v_exp_f32 v161, v161
    v_exp_f32 v162, v162
    s_waitcnt lgkmcnt(8)
    s_add_u32 m0, s76, 2048
    s_add_u32 s81, s81, 16384
    s_and_b32 s81, s81, 262143
    buffer_load_dwordx4 v12, s[40:43], s81 offen lds
    buffer_load_dwordx4 v13, s[40:43], s81 offen offset:1024 lds
    s_waitcnt vmcnt(17)
    ds_read_b64_tr_b16 a[16:17], v27 offset:8192
    ds_read_b64_tr_b16 a[18:19], v27 offset:9216
    ds_read_b64_tr_b16 a[144:145], v28 offset:8192
    ds_read_b64_tr_b16 a[146:147], v28 offset:9216
    v_exp_f32 v163, v163
    v_exp_f32 v164, v164
    v_exp_f32 v165, v165
    v_exp_f32 v166, v166
    v_exp_f32 v167, v167
    v_exp_f32 v168, v168
    v_exp_f32 v169, v169
    v_exp_f32 v170, v170
    v_exp_f32 v171, v171
    v_exp_f32 v172, v172
    v_exp_f32 v173, v173
    v_exp_f32 v174, v174
    s_waitcnt lgkmcnt(8)
    s_add_u32 m0, s76, 4096
    s_add_u32 s81, s81, 16384
    s_and_b32 s81, s81, 262143
    buffer_load_dwordx4 v12, s[40:43], s81 offen lds
    buffer_load_dwordx4 v13, s[40:43], s81 offen offset:1024 lds
    s_waitcnt vmcnt(17)
    ds_read_b64_tr_b16 a[20:21], v27 offset:10240
    ds_read_b64_tr_b16 a[22:23], v27 offset:11264
    ds_read_b64_tr_b16 a[148:149], v28 offset:10240
    ds_read_b64_tr_b16 a[150:151], v28 offset:11264
    v_exp_f32 v175, v175
    v_pk_add_f32 v[56:57], v[160:161], v[162:163]
    v_pk_add_f32 v[58:59], v[164:165], v[166:167]
    v_pk_add_f32 v[56:57], v[56:57], v[168:169]
    v_pk_add_f32 v[58:59], v[58:59], v[170:171]
    v_pk_add_f32 v[56:57], v[56:57], v[172:173]
    v_pk_add_f32 v[58:59], v[58:59], v[174:175]
    v_pk_add_f32 v[56:57], v[56:57], v[58:59]
    v_add_f32 v56, v56, v57
    v_rcp_f32 v56, v56
    s_nop 0
    v_pk_mul_f32 v[160:161], v[160:161], v[56:57] op_sel_hi:[1,0]
    v_pk_mul_f32 v[162:163], v[162:163], v[56:57] op_sel_hi:[1,0]
    v_pk_mul_f32 v[164:165], v[164:165], v[56:57] op_sel_hi:[1,0]
    s_waitcnt lgkmcnt(8)
    s_add_u32 m0, s76, 6144
    s_add_u32 s81, s81, 16384
    s_and_b32 s81, s81, 262143
    buffer_load_dwordx4 v12, s[40:43], s81 offen lds
    buffer_load_dwordx4 v13, s[40:43], s81 offen offset:1024 lds
    s_waitcnt vmcnt(17)
    ds_read_b64_tr_b16 a[24:25], v27 offset:12288
    ds_read_b64_tr_b16 a[26:27], v27 offset:13312
    ds_read_b64_tr_b16 a[152:153], v28 offset:12288
    ds_read_b64_tr_b16 a[154:155], v28 offset:13312
    v_pk_mul_f32 v[166:167], v[166:167], v[56:57] op_sel_hi:[1,0]
    v_pk_mul_f32 v[168:169], v[168:169], v[56:57] op_sel_hi:[1,0]
    v_pk_mul_f32 v[170:171], v[170:171], v[56:57] op_sel_hi:[1,0]
    v_pk_mul_f32 v[172:173], v[172:173], v[56:57] op_sel_hi:[1,0]
    v_pk_mul_f32 v[174:175], v[174:175], v[56:57] op_sel_hi:[1,0]
    v_cvt_pk_bf16_f32 v160, v160, v161
    v_cvt_pk_bf16_f32 v161, v162, v163
    v_cvt_pk_bf16_f32 v162, v164, v165
    v_cvt_pk_bf16_f32 v163, v166, v167
    v_cvt_pk_bf16_f32 v164, v168, v169
    v_cvt_pk_bf16_f32 v165, v170, v171
    v_cvt_pk_bf16_f32 v166, v172, v173
    v_cvt_pk_bf16_f32 v167, v174, v175
    s_waitcnt lgkmcnt(8)
    s_add_u32 m0, s76, 8192
    s_add_u32 s81, s81, 16384
    s_and_b32 s81, s81, 262143
    buffer_load_dwordx4 v12, s[40:43], s81 offen lds
    buffer_load_dwordx4 v13, s[40:43], s81 offen offset:1024 lds
    s_waitcnt vmcnt(17)
    ds_read_b64_tr_b16 a[28:29], v27 offset:14336
    ds_read_b64_tr_b16 a[30:31], v27 offset:15360
    ds_read_b64_tr_b16 a[156:157], v28 offset:14336
    ds_read_b64_tr_b16 a[158:159], v28 offset:15360
    v_max3_f32 v56, v176, v177, v178
    v_max3_f32 v57, v179, v180, v181
    v_max3_f32 v56, v56, v182, v183
    v_max3_f32 v57, v57, v184, v185
    v_max3_f32 v56, v56, v186, v187
    v_max3_f32 v57, v57, v188, v189
    v_max3_f32 v56, v56, v190, v191
    v_max_f32 v56, v56, v57
    v_mul_f32_e64 v56, -v56, s98
    v_pk_fma_f32 v[176:177], v[176:177], s[98:99], v[56:57] op_sel_hi:[1,0,0]
    v_pk_fma_f32 v[178:179], v[178:179], s[98:99], v[56:57] op_sel_hi:[1,0,0]
    v_pk_fma_f32 v[180:181], v[180:181], s[98:99], v[56:57] op_sel_hi:[1,0,0]
    s_waitcnt lgkmcnt(8)
    s_add_u32 m0, s76, 10240
    s_lshl_b32 s71, s56, 4
    s_sub_u32 s71, s78, s71
    s_lshl_b32 s71, s71, 14
    v_add_u32 v12, s71, v12
    v_add_u32 v13, s71, v13
    s_lshr_b32 s81, s65, 2
    s_lshl_b32 s81, s81, 14
    buffer_load_dwordx4 v12, s[40:43], s81 offen lds
    buffer_load_dwordx4 v13, s[40:43], s81 offen offset:1024 lds
    s_waitcnt vmcnt(17)
    ds_read_b64_tr_b16 a[120:121], v27 offset:16384
    ds_read_b64_tr_b16 a[122:123], v27 offset:17408
    ds_read_b64_tr_b16 a[248:249], v28 offset:16384
    ds_read_b64_tr_b16 a[250:251], v28 offset:17408
    v_pk_fma_f32 v[182:183], v[182:183], s[98:99], v[56:57] op_sel_hi:[1,0,0]
    v_pk_fma_f32 v[184:185], v[184:185], s[98:99], v[56:57] op_sel_hi:[1,0,0]
    v_pk_fma_f32 v[186:187], v[186:187], s[98:99], v[56:57] op_sel_hi:[1,0,0]
    v_pk_fma_f32 v[188:189], v[188:189], s[98:99], v[56:57] op_sel_hi:[1,0,0]
    v_pk_fma_f32 v[190:191], v[190:191], s[98:99], v[56:57] op_sel_hi:[1,0,0]
    v_exp_f32 v176, v176
    v_exp_f32 v177, v177
    v_exp_f32 v178, v178
    v_exp_f32 v179, v179
    v_exp_f32 v180, v180
    v_exp_f32 v181, v181
    v_exp_f32 v182, v182
    v_exp_f32 v183, v183
    s_waitcnt lgkmcnt(8)
    s_add_u32 m0, s76, 12288
    s_add_u32 s81, s81, 16384
    s_cmp_eq_u32 s81, s79
    s_cselect_b32 s81, 0, s81
    buffer_load_dwordx4 v12, s[40:43], s81 offen lds
    buffer_load_dwordx4 v13, s[40:43], s81 offen offset:1024 lds
    s_waitcnt vmcnt(17)
    ds_read_b64_tr_b16 a[124:125], v27 offset:18432
    ds_read_b64_tr_b16 a[126:127], v27 offset:19456
    ds_read_b64_tr_b16 a[252:253], v28 offset:18432
    ds_read_b64_tr_b16 a[254:255], v28 offset:19456
    v_exp_f32 v184, v184
    v_exp_f32 v185, v185
    v_exp_f32 v186, v186
    v_exp_f32 v187, v187
    v_exp_f32 v188, v188
    v_exp_f32 v189, v189
    v_exp_f32 v190, v190
    v_exp_f32 v191, v191
    v_pk_add_f32 v[56:57], v[176:177], v[178:179]
    v_pk_add_f32 v[58:59], v[180:181], v[182:183]
    v_pk_add_f32 v[56:57], v[56:57], v[184:185]
    v_pk_add_f32 v[58:59], v[58:59], v[186:187]
    s_waitcnt lgkmcnt(8)
    s_add_u32 m0, s76, 14336
    s_add_u32 s81, s81, 16384
    s_cmp_eq_u32 s81, s79
    s_cselect_b32 s81, 0, s81
    buffer_load_dwordx4 v12, s[40:43], s81 offen lds
    buffer_load_dwordx4 v13, s[40:43], s81 offen offset:1024 lds
    s_waitcnt vmcnt(17)
    ds_read_b64_tr_b16 v[14:15], v27 offset:20480
    ds_read_b64_tr_b16 v[16:17], v27 offset:21504
    ds_read_b64_tr_b16 v[18:19], v28 offset:20480
    ds_read_b64_tr_b16 v[20:21], v28 offset:21504
    v_pk_add_f32 v[56:57], v[56:57], v[188:189]
    v_pk_add_f32 v[58:59], v[58:59], v[190:191]
    v_pk_add_f32 v[56:57], v[56:57], v[58:59]
    v_add_f32 v56, v56, v57
    v_rcp_f32 v56, v56
    s_nop 0
    v_pk_mul_f32 v[176:177], v[176:177], v[56:57] op_sel_hi:[1,0]
    v_pk_mul_f32 v[178:179], v[178:179], v[56:57] op_sel_hi:[1,0]
    v_pk_mul_f32 v[180:181], v[180:181], v[56:57] op_sel_hi:[1,0]
    v_pk_mul_f32 v[182:183], v[182:183], v[56:57] op_sel_hi:[1,0]
    v_pk_mul_f32 v[184:185], v[184:185], v[56:57] op_sel_hi:[1,0]
    v_pk_mul_f32 v[186:187], v[186:187], v[56:57] op_sel_hi:[1,0]
    v_pk_mul_f32 v[188:189], v[188:189], v[56:57] op_sel_hi:[1,0]
    v_pk_mul_f32 v[190:191], v[190:191], v[56:57] op_sel_hi:[1,0]
    s_waitcnt lgkmcnt(8)
    s_add_u32 m0, s76, 16384
    s_add_u32 s81, s81, 16384
    s_cmp_eq_u32 s81, s79
    s_cselect_b32 s81, 0, s81
    buffer_load_dwordx4 v12, s[40:43], s81 offen lds
    buffer_load_dwordx4 v13, s[40:43], s81 offen offset:1024 lds
    v_cvt_pk_bf16_f32 v176, v176, v177
    v_cvt_pk_bf16_f32 v177, v178, v179
    v_cvt_pk_bf16_f32 v178, v180, v181
    v_cvt_pk_bf16_f32 v179, v182, v183
    v_cvt_pk_bf16_f32 v180, v184, v185
    v_cvt_pk_bf16_f32 v181, v186, v187
    v_cvt_pk_bf16_f32 v182, v188, v189
    v_cvt_pk_bf16_f32 v183, v190, v191
    buffer_load_dword v36, v35, s[48:51], s101 offen offset:0 sc1
    v_max3_f32 v56, v192, v193, v194
    v_max3_f32 v57, v195, v196, v197
    v_max3_f32 v56, v56, v198, v199
    v_max3_f32 v57, v57, v200, v201
    v_max3_f32 v56, v56, v202, v203
    v_max3_f32 v57, v57, v204, v205
    v_max3_f32 v56, v56, v206, v207
    v_max_f32 v56, v56, v57
    v_mul_f32_e64 v56, -v56, s98
    s_waitcnt lgkmcnt(4)
    s_add_u32 m0, s76, 18432
    s_add_u32 s81, s81, 16384
    s_cmp_eq_u32 s81, s79
    s_cselect_b32 s81, 0, s81
    buffer_load_dwordx4 v12, s[40:43], s81 offen lds
    buffer_load_dwordx4 v13, s[40:43], s81 offen offset:1024 lds
    v_pk_fma_f32 v[192:193], v[192:193], s[98:99], v[56:57] op_sel_hi:[1,0,0]
    v_pk_fma_f32 v[194:195], v[194:195], s[98:99], v[56:57] op_sel_hi:[1,0,0]
    v_pk_fma_f32 v[196:197], v[196:197], s[98:99], v[56:57] op_sel_hi:[1,0,0]
    v_pk_fma_f32 v[198:199], v[198:199], s[98:99], v[56:57] op_sel_hi:[1,0,0]
    v_pk_fma_f32 v[200:201], v[200:201], s[98:99], v[56:57] op_sel_hi:[1,0,0]
    v_pk_fma_f32 v[202:203], v[202:203], s[98:99], v[56:57] op_sel_hi:[1,0,0]
    v_pk_fma_f32 v[204:205], v[204:205], s[98:99], v[56:57] op_sel_hi:[1,0,0]
    v_pk_fma_f32 v[206:207], v[206:207], s[98:99], v[56:57] op_sel_hi:[1,0,0]
    v_exp_f32 v192, v192
    v_exp_f32 v193, v193
    v_exp_f32 v194, v194
    v_exp_f32 v195, v195
    v_exp_f32 v196, v196
    v_exp_f32 v197, v197
    v_exp_f32 v198, v198
    v_exp_f32 v199, v199
    v_exp_f32 v200, v200
    v_exp_f32 v201, v201
    v_exp_f32 v202, v202
    v_exp_f32 v203, v203
    v_exp_f32 v204, v204
    v_exp_f32 v205, v205
    v_exp_f32 v206, v206
    v_exp_f32 v207, v207
    v_pk_add_f32 v[56:57], v[192:193], v[194:195]
    v_pk_add_f32 v[58:59], v[196:197], v[198:199]
    v_pk_add_f32 v[56:57], v[56:57], v[200:201]
    v_pk_add_f32 v[58:59], v[58:59], v[202:203]
    v_pk_add_f32 v[56:57], v[56:57], v[204:205]
    s_waitcnt lgkmcnt(0)
    s_add_u32 m0, s76, 20480
    s_add_u32 s81, s81, 16384
    s_cmp_eq_u32 s81, s79
    s_cselect_b32 s81, 0, s81
    s_cmp_ge_u32 s56, 2
    s_cbranch_scc1 LQ_skip33
    buffer_load_dwordx4 v12, s[40:43], s81 offen lds
    buffer_load_dwordx4 v13, s[40:43], s81 offen offset:1024 lds
LQ_skip33:
    v_pk_add_f32 v[58:59], v[58:59], v[206:207]
    v_pk_add_f32 v[56:57], v[56:57], v[58:59]
    v_add_f32 v56, v56, v57
    v_rcp_f32 v56, v56
    s_nop 0
    v_pk_mul_f32 v[192:193], v[192:193], v[56:57] op_sel_hi:[1,0]
    v_pk_mul_f32 v[194:195], v[194:195], v[56:57] op_sel_hi:[1,0]
    v_pk_mul_f32 v[196:197], v[196:197], v[56:57] op_sel_hi:[1,0]
    v_pk_mul_f32 v[198:199], v[198:199], v[56:57] op_sel_hi:[1,0]
    v_pk_mul_f32 v[200:201], v[200:201], v[56:57] op_sel_hi:[1,0]
    v_pk_mul_f32 v[202:203], v[202:203], v[56:57] op_sel_hi:[1,0]
    v_pk_mul_f32 v[204:205], v[204:205], v[56:57] op_sel_hi:[1,0]
    v_pk_mul_f32 v[206:207], v[206:207], v[56:57] op_sel_hi:[1,0]
    v_cvt_pk_bf16_f32 v192, v192, v193
    v_cvt_pk_bf16_f32 v193, v194, v195
    v_cvt_pk_bf16_f32 v194, v196, v197
    v_cvt_pk_bf16_f32 v195, v198, v199
    v_cvt_pk_bf16_f32 v196, v200, v201
    v_cvt_pk_bf16_f32 v197, v202, v203
    v_cvt_pk_bf16_f32 v198, v204, v205
    v_cvt_pk_bf16_f32 v199, v206, v207
    s_waitcnt vmcnt(2)
    v_cmp_ne_u32 vcc, s64, v36
    s_nop 1
    s_cbranch_vccnz LQ_pdone35_ool2
LQ_pdone35:
    v_max3_f32 v56, v208, v209, v210
    v_max3_f32 v57, v211, v212, v213
    v_max3_f32 v56, v56, v214, v215
    buffer_load_dwordx4 a[56:59], v31, s[48:51], s82 offen sc1
    buffer_load_dwordx4 a[184:187], v32, s[48:51], s82 offen sc1
    s_add_u32 s82, s82, 1024
    s_and_b32 s82, s82, 16383
    v_max3_f32 v57, v57, v216, v217
    v_max3_f32 v56, v56, v218, v219
    v_max3_f32 v57, v57, v220, v221
    v_max3_f32 v56, v56, v222, v223
    v_max_f32 v56, v56, v57
    v_mul_f32_e64 v56, -v56, s98
    v_pk_fma_f32 v[208:209], v[208:209], s[98:99], v[56:57] op_sel_hi:[1,0,0]
    buffer_load_dwordx4 a[60:63], v31, s[48:51], s82 offen sc1
    buffer_load_dwordx4 a[188:191], v32, s[48:51], s82 offen sc1
    s_add_u32 s82, s82, 1024
    s_and_b32 s82, s82, 16383
    v_pk_fma_f32 v[210:211], v[210:211], s[98:99], v[56:57] op_sel_hi:[1,0,0]
    v_pk_fma_f32 v[212:213], v[212:213], s[98:99], v[56:57] op_sel_hi:[1,0,0]
    v_pk_fma_f32 v[214:215], v[214:215], s[98:99], v[56:57] op_sel_hi:[1,0,0]
    v_pk_fma_f32 v[216:217], v[216:217], s[98:99], v[56:57] op_sel_hi:[1,0,0]
    v_pk_fma_f32 v[218:219], v[218:219], s[98:99], v[56:57] op_sel_hi:[1,0,0]
    v_pk_fma_f32 v[220:221], v[220:221], s[98:99], v[56:57] op_sel_hi:[1,0,0]
    v_pk_fma_f32 v[222:223], v[222:223], s[98:99], v[56:57] op_sel_hi:[1,0,0]
    buffer_load_dwordx4 a[64:67], v31, s[48:51], s82 offen sc1
    buffer_load_dwordx4 a[192:195], v32, s[48:51], s82 offen sc1
    s_add_u32 s82, s82, 1024
    s_and_b32 s82, s82, 16383
    v_exp_f32 v208, v208
    v_exp_f32 v209, v209
    v_exp_f32 v210, v210
    v_exp_f32 v211, v211
    v_exp_f32 v212, v212
    v_exp_f32 v213, v213
    v_exp_f32 v214, v214
    buffer_load_dwordx4 a[68:71], v31, s[48:51], s82 offen sc1
    buffer_load_dwordx4 a[196:199], v32, s[48:51], s82 offen sc1
    s_add_u32 s82, s82, 1024
    s_and_b32 s82, s82, 16383
    v_exp_f32 v215, v215
    v_exp_f32 v216, v216
    v_exp_f32 v217, v217
    v_exp_f32 v218, v218
    v_exp_f32 v219, v219
    v_exp_f32 v220, v220
    v_exp_f32 v221, v221
    v_exp_f32 v222, v222
    buffer_load_dwordx4 a[72:75], v31, s[48:51], s82 offen sc1
    buffer_load_dwordx4 a[200:203], v32, s[48:51], s82 offen sc1
    s_add_u32 s82, s82, 1024
    s_and_b32 s82, s82, 16383
    v_exp_f32 v223, v223
    v_pk_add_f32 v[56:57], v[208:209], v[210:211]
    v_pk_add_f32 v[58:59], v[212:213], v[214:215]
    v_pk_add_f32 v[56:57], v[56:57], v[216:217]
    v_pk_add_f32 v[58:59], v[58:59], v[218:219]
    v_pk_add_f32 v[56:57], v[56:57], v[220:221]
    v_pk_add_f32 v[58:59], v[58:59], v[222:223]
    buffer_load_dwordx4 a[76:79], v31, s[48:51], s82 offen sc1
    buffer_load_dwordx4 a[204:207], v32, s[48:51], s82 offen sc1
    s_add_u32 s82, s82, 1024
    s_and_b32 s82, s82, 16383
    v_pk_add_f32 v[56:57], v[56:57], v[58:59]
    v_add_f32 v56, v56, v57
    v_rcp_f32 v56, v56
    s_nop 0
    v_pk_mul_f32 v[208:209], v[208:209], v[56:57] op_sel_hi:[1,0]
    v_pk_mul_f32 v[210:211], v[210:211], v[56:57] op_sel_hi:[1,0]
    v_pk_mul_f32 v[212:213], v[212:213], v[56:57] op_sel_hi:[1,0]
    v_pk_mul_f32 v[214:215], v[214:215], v[56:57] op_sel_hi:[1,0]
    buffer_load_dwordx4 a[80:83], v31, s[48:51], s82 offen sc1
    buffer_load_dwordx4 a[208:211], v32, s[48:51], s82 offen sc1
    s_add_u32 s82, s82, 1024
    s_and_b32 s82, s82, 16383
    v_pk_mul_f32 v[216:217], v[216:217], v[56:57] op_sel_hi:[1,0]
    v_pk_mul_f32 v[218:219], v[218:219], v[56:57] op_sel_hi:[1,0]
    v_pk_mul_f32 v[220:221], v[220:221], v[56:57] op_sel_hi:[1,0]
    v_pk_mul_f32 v[222:223], v[222:223], v[56:57] op_sel_hi:[1,0]
    v_cvt_pk_bf16_f32 v208, v208, v209
    v_cvt_pk_bf16_f32 v209, v210, v211
    v_cvt_pk_bf16_f32 v210, v212, v213
    buffer_load_dwordx4 a[84:87], v31, s[48:51], s82 offen sc1
    buffer_load_dwordx4 a[212:215], v32, s[48:51], s82 offen sc1
    s_add_u32 s82, s82, 1024
    s_and_b32 s82, s82, 16383
    v_cvt_pk_bf16_f32 v211, v214, v215
    v_cvt_pk_bf16_f32 v212, v216, v217
    v_cvt_pk_bf16_f32 v213, v218, v219
    v_cvt_pk_bf16_f32 v214, v220, v221
    v_cvt_pk_bf16_f32 v215, v222, v223
    v_and_b32 v35, 31, v1
    v_lshlrev_b32 v35, 2, v35
    s_and_b32 s69, s100, 255
    s_lshl_b32 s69, s69, 6
    s_add_u32 s27, s69, 10510336
    buffer_load_dword v36, v35, s[48:51], s27 offen offset:0 sc1
    s_waitcnt lgkmcnt(15)
    s_waitcnt vmcnt(15)
    v_mfma_f32_32x32x16_bf16 v[64:79], a[0:3], a[56:59], 0
    buffer_load_dwordx4 a[88:91], v31, s[48:51], s82 offen sc1
    v_mfma_f32_32x32x16_bf16 v[80:95], a[0:3], a[184:187], 0
    buffer_load_dwordx4 a[216:219], v32, s[48:51], s82 offen sc1
    v_mfma_f32_32x32x16_bf16 v[96:111], a[128:131], a[56:59], 0
    s_add_u32 s82, s82, 1024
    s_and_b32 s82, s82, 16383
    v_mfma_f32_32x32x16_bf16 v[112:127], a[128:131], a[184:187], 0
    s_waitcnt lgkmcnt(15)
    s_waitcnt vmcnt(15)
    v_mfma_f32_32x32x16_bf16 v[64:79], a[4:7], a[60:63], v[64:79]
    buffer_load_dwordx4 a[92:95], v31, s[48:51], s82 offen sc1
    v_mfma_f32_32x32x16_bf16 v[80:95], a[4:7], a[188:191], v[80:95]
    buffer_load_dwordx4 a[220:223], v32, s[48:51], s82 offen sc1
    v_mfma_f32_32x32x16_bf16 v[96:111], a[132:135], a[60:63], v[96:111]
    s_add_u32 s82, s82, 1024
    s_and_b32 s82, s82, 16383
    v_mfma_f32_32x32x16_bf16 v[112:127], a[132:135], a[188:191], v[112:127]
    v_lshlrev_b32 v57, 4, v1
    v_lshlrev_b32 v58, 2, v1
    s_add_u32 s69, s26, 4096
    s_add_u32 s68, s77, 12288
    v_lshl_add_u32 v6, v1, 3, s68
    v_lshrrev_b32 v56, 5, v1
    v_mul_u32_u24 v59, 2016, v56
    v_lshl_add_u32 v59, v35, 4, v59
    s_add_u32 s70, s68, 32
    v_add_u32 v7, s70, v59
    v_bfe_u32 v59, v1, 2, 2
    v_lshl_add_u32 v59, v56, 4, v59
    v_lshlrev_b32 v59, 6, v59
    v_bfe_u32 v56, v1, 4, 1
    v_lshl_add_u32 v59, v56, 5, v59
    v_and_b32 v56, 3, v1
    v_lshl_add_u32 v59, v56, 3, v59
    v_add_u32 v8, s68, v59
    s_waitcnt vmcnt(4)
    v_cmp_ne_u32 vcc, s64, v36
    s_nop 1
    s_cbranch_vccnz LQ_pdone43_ool3
LQ_pdone43:
    buffer_load_dwordx4 v[128:131], v57, s[48:51], s26 offen offset:0 sc1
    buffer_load_dwordx4 v[132:135], v57, s[48:51], s26 offen offset:1024 sc1
    buffer_load_dwordx4 v[136:139], v57, s[48:51], s26 offen offset:2048 sc1
    buffer_load_dwordx4 v[140:143], v57, s[48:51], s26 offen offset:3072 sc1
    buffer_load_dword v144, v58, s[48:51], s69 offen sc1
    buffer_load_dwordx4 a[96:99], v31, s[48:51], s82 offen sc1
    buffer_load_dwordx4 a[224:227], v32, s[48:51], s82 offen sc1
    s_add_u32 s82, s82, 1024
    s_and_b32 s82, s82, 16383
    v_and_b32 v35, 15, v1
    v_lshlrev_b32 v35, 2, v35
    s_lshl_b32 s68, s58, 2
    s_lshl_b32 s69, s61, 1
    s_add_u32 s68, s68, s69
    s_add_u32 s68, s68, 86
    s_lshl_b32 s27, s68, 10
    s_waitcnt lgkmcnt(15)
    s_waitcnt vmcnt(22)
    v_mfma_f32_32x32x16_bf16 v[64:79], a[8:11], a[64:67], v[64:79]
    buffer_load_dwordx4 a[100:103], v31, s[48:51], s82 offen sc1
    v_mfma_f32_32x32x16_bf16 v[80:95], a[8:11], a[192:195], v[80:95]
    buffer_load_dwordx4 a[228:231], v32, s[48:51], s82 offen sc1
    v_mfma_f32_32x32x16_bf16 v[96:111], a[136:139], a[64:67], v[96:111]
    s_add_u32 s82, s82, 1024
    s_and_b32 s82, s82, 16383
    v_mfma_f32_32x32x16_bf16 v[112:127], a[136:139], a[192:195], v[112:127]
    s_waitcnt lgkmcnt(15)
    s_waitcnt vmcnt(22)
    v_mfma_f32_32x32x16_bf16 v[64:79], a[12:15], a[68:71], v[64:79]
    buffer_load_dwordx4 a[104:107], v31, s[48:51], s82 offen sc1
    v_mfma_f32_32x32x16_bf16 v[80:95], a[12:15], a[196:199], v[80:95]
    buffer_load_dwordx4 a[232:235], v32, s[48:51], s82 offen sc1
    v_mfma_f32_32x32x16_bf16 v[96:111], a[140:143], a[68:71], v[96:111]
    s_add_u32 s82, s82, 1024
    s_and_b32 s82, s82, 16383
    s_add_u32 m0, s77, 0
    s_lshl_b32 s71, s56, 3
    s_sub_u32 s71, s71, s78
    s_lshl_b32 s71, s71, 14
    v_add_u32 v12, s71, v12
    v_add_u32 v13, s71, v13
    s_lshr_b32 s81, s65, 1
    s_lshl_b32 s81, s81, 14
    buffer_load_dwordx4 v12, s[44:47], s81 offen lds
    v_mfma_f32_32x32x16_bf16 v[112:127], a[140:143], a[196:199], v[112:127]
    buffer_load_dwordx4 v13, s[44:47], s81 offen offset:1024 lds
    s_waitcnt lgkmcnt(15)
    s_waitcnt vmcnt(24)
    v_mfma_f32_32x32x16_bf16 v[64:79], a[16:19], a[72:75], v[64:79]
    buffer_load_dwordx4 a[108:111], v31, s[48:51], s82 offen sc1
    v_mfma_f32_32x32x16_bf16 v[80:95], a[16:19], a[200:203], v[80:95]
    buffer_load_dwordx4 a[236:239], v32, s[48:51], s82 offen sc1
    v_mfma_f32_32x32x16_bf16 v[96:111], a[144:147], a[72:75], v[96:111]
    s_add_u32 s82, s82, 1024
    s_and_b32 s82, s82, 16383
    v_mfma_f32_32x32x16_bf16 v[112:127], a[144:147], a[200:203], v[112:127]
    s_waitcnt lgkmcnt(15)
    s_waitcnt vmcnt(24)
    v_mfma_f32_32x32x16_bf16 v[64:79], a[20:23], a[76:79], v[64:79]
    buffer_load_dwordx4 a[112:115], v31, s[48:51], s82 offen sc1
    v_mfma_f32_32x32x16_bf16 v[80:95], a[20:23], a[204:207], v[80:95]
    buffer_load_dwordx4 a[240:243], v32, s[48:51], s82 offen sc1
    v_mfma_f32_32x32x16_bf16 v[96:111], a[148:151], a[76:79], v[96:111]
    s_add_u32 s82, s82, 1024
    s_and_b32 s82, s82, 16383
    s_add_u32 m0, s77, 2048
    s_add_u32 s81, s81, 16384
    s_and_b32 s81, s81, 131071
    buffer_load_dwordx4 v12, s[44:47], s81 offen lds
    v_mfma_f32_32x32x16_bf16 v[112:127], a[148:151], a[204:207], v[112:127]
    buffer_load_dwordx4 v13, s[44:47], s81 offen offset:1024 lds
    s_waitcnt vmcnt(14)
    v_cvt_pk_bf16_f32 v128, v128, v129
    v_cvt_pk_bf16_f32 v129, v130, v131
    ds_write_b64 v6, v[128:129] offset:0
    ds_write_b64 v6, v[128:129] offset:2048
    v_cvt_pk_bf16_f32 v132, v132, v133
    v_cvt_pk_bf16_f32 v133, v134, v135
    ds_write_b64 v6, v[132:133] offset:512
    ds_write_b64 v6, v[132:133] offset:2560
    v_cvt_pk_bf16_f32 v136, v136, v137
    v_cvt_pk_bf16_f32 v137, v138, v139
    ds_write_b64 v6, v[136:137] offset:1024
    ds_write_b64 v6, v[136:137] offset:3072
    v_cvt_pk_bf16_f32 v140, v140, v141
    v_cvt_pk_bf16_f32 v141, v142, v143
    ds_write_b64 v6, v[140:141] offset:1536
    ds_write_b64 v6, v[140:141] offset:3584
    v_cvt_pk_bf16_f32 v144, v144, v144
    ds_write_b16 v7, v144
    ds_write_b16 v7, v144 offset:8
    ds_read_b64_tr_b16 v[224:225], v8 offset:0
    ds_read_b64_tr_b16 v[226:227], v8 offset:256
    ds_read_b64_tr_b16 v[228:229], v8 offset:512
    ds_read_b64_tr_b16 v[230:231], v8 offset:768
    ds_read_b64_tr_b16 v[232:233], v8 offset:2048
    ds_read_b64_tr_b16 v[234:235], v8 offset:2304
    ds_read_b64_tr_b16 v[236:237], v8 offset:2560
    ds_read_b64_tr_b16 v[238:239], v8 offset:2816
    s_waitcnt lgkmcnt(4)
    v_mfma_f32_32x32x16_bf16 v[240:255], v[224:227], v[160:163], 0
    v_mfma_f32_32x32x16_bf16 v[240:255], v[228:231], v[164:167], v[240:255]
    s_waitcnt lgkmcnt(0)
    v_mfma_f32_32x32x16_bf16 v[128:143], v[232:235], v[176:179], 0
    v_mfma_f32_32x32x16_bf16 v[128:143], v[236:239], v[180:183], v[128:143]
    v_mfma_f32_32x32x16_bf16 v[144:159], v[224:227], v[192:195], 0
    v_mfma_f32_32x32x16_bf16 v[144:159], v[228:231], v[196:199], v[144:159]
    s_nop 6
    v_add_f32 v60, 0x358637bd, v248
    v_rcp_f32 v60, v60
    s_nop 0
    v_pk_mul_f32 v[240:241], v[240:241], v[60:61] op_sel_hi:[1,0]
    v_pk_mul_f32 v[242:243], v[242:243], v[60:61] op_sel_hi:[1,0]
    v_pk_mul_f32 v[244:245], v[244:245], v[60:61] op_sel_hi:[1,0]
    v_pk_mul_f32 v[246:247], v[246:247], v[60:61] op_sel_hi:[1,0]
    v_cvt_pk_bf16_f32 v168, v240, v241
    v_cvt_pk_bf16_f32 v169, v242, v243
    v_cvt_pk_bf16_f32 v170, v244, v245
    v_cvt_pk_bf16_f32 v171, v246, v247
    buffer_store_dwordx4 v[168:171], v33, s[48:51], s27 offen offset:0 sc1
    v_mfma_f32_32x32x16_bf16 v[240:255], v[232:235], v[208:211], 0
    v_mfma_f32_32x32x16_bf16 v[240:255], v[236:239], v[212:215], v[240:255]
    v_add_f32 v60, 0x358637bd, v128
    v_rcp_f32 v60, v60
    s_nop 0
    v_pk_mul_f32 v[136:137], v[136:137], v[60:61] op_sel_hi:[1,0]
    v_pk_mul_f32 v[138:139], v[138:139], v[60:61] op_sel_hi:[1,0]
    v_pk_mul_f32 v[140:141], v[140:141], v[60:61] op_sel_hi:[1,0]
    v_pk_mul_f32 v[142:143], v[142:143], v[60:61] op_sel_hi:[1,0]
    v_cvt_pk_bf16_f32 v184, v136, v137
    v_cvt_pk_bf16_f32 v185, v138, v139
    v_cvt_pk_bf16_f32 v186, v140, v141
    v_cvt_pk_bf16_f32 v187, v142, v143
    buffer_store_dwordx4 v[184:187], v33, s[48:51], s27 offen offset:1024 sc1
    v_add_f32 v60, 0x358637bd, v152
    v_rcp_f32 v60, v60
    s_nop 0
    v_pk_mul_f32 v[144:145], v[144:145], v[60:61] op_sel_hi:[1,0]
    v_pk_mul_f32 v[146:147], v[146:147], v[60:61] op_sel_hi:[1,0]
    v_pk_mul_f32 v[148:149], v[148:149], v[60:61] op_sel_hi:[1,0]
    v_pk_mul_f32 v[150:151], v[150:151], v[60:61] op_sel_hi:[1,0]
    v_cvt_pk_bf16_f32 v200, v144, v145
    v_cvt_pk_bf16_f32 v201, v146, v147
    v_cvt_pk_bf16_f32 v202, v148, v149
    v_cvt_pk_bf16_f32 v203, v150, v151
    buffer_store_dwordx4 v[200:203], v34, s[48:51], s27 offen offset:0 sc1
    v_add_f32 v60, 0x358637bd, v240
    v_rcp_f32 v60, v60
    s_nop 0
    v_pk_mul_f32 v[248:249], v[248:249], v[60:61] op_sel_hi:[1,0]
    v_pk_mul_f32 v[250:251], v[250:251], v[60:61] op_sel_hi:[1,0]
    v_pk_mul_f32 v[252:253], v[252:253], v[60:61] op_sel_hi:[1,0]
    v_pk_mul_f32 v[254:255], v[254:255], v[60:61] op_sel_hi:[1,0]
    v_cvt_pk_bf16_f32 v216, v248, v249
    v_cvt_pk_bf16_f32 v217, v250, v251
    v_cvt_pk_bf16_f32 v218, v252, v253
    v_cvt_pk_bf16_f32 v219, v254, v255
    buffer_store_dwordx4 v[216:219], v34, s[48:51], s27 offen offset:1024 sc1
    buffer_load_dwordx4 a[116:119], v31, s[48:51], s82 offen sc1
    buffer_load_dwordx4 a[244:247], v32, s[48:51], s82 offen sc1
    s_waitcnt lgkmcnt(15)
    s_waitcnt vmcnt(32)
    v_mfma_f32_32x32x16_bf16 v[64:79], a[24:27], a[80:83], v[64:79]
    s_add_u32 m0, s77, 4096
    s_add_u32 s81, s81, 16384
    s_and_b32 s81, s81, 131071
    buffer_load_dwordx4 v12, s[44:47], s81 offen lds
    v_mfma_f32_32x32x16_bf16 v[80:95], a[24:27], a[208:211], v[80:95]
    v_mfma_f32_32x32x16_bf16 v[96:111], a[152:155], a[80:83], v[96:111]
    buffer_load_dwordx4 v13, s[44:47], s81 offen offset:1024 lds
    v_mfma_f32_32x32x16_bf16 v[112:127], a[152:155], a[208:211], v[112:127]
    s_waitcnt lgkmcnt(15)
    s_waitcnt vmcnt(32)
    v_mfma_f32_32x32x16_bf16 v[64:79], a[28:31], a[84:87], v[64:79]
    s_add_u32 m0, s77, 6144
    s_add_u32 s81, s81, 16384
    s_and_b32 s81, s81, 131071
    buffer_load_dwordx4 v12, s[44:47], s81 offen lds
    v_mfma_f32_32x32x16_bf16 v[80:95], a[28:31], a[212:215], v[80:95]
    v_mfma_f32_32x32x16_bf16 v[96:111], a[156:159], a[84:87], v[96:111]
    buffer_load_dwordx4 v13, s[44:47], s81 offen offset:1024 lds
    v_mfma_f32_32x32x16_bf16 v[112:127], a[156:159], a[212:215], v[112:127]
    s_waitcnt lgkmcnt(15)
    s_waitcnt vmcnt(31)
    v_mfma_f32_32x32x16_bf16 v[64:79], a[120:123], a[88:91], v[64:79]
    s_add_u32 m0, s77, 8192
    s_add_u32 s81, s81, 16384
    s_and_b32 s81, s81, 131071
    buffer_load_dwordx4 v12, s[44:47], s81 offen lds
    v_mfma_f32_32x32x16_bf16 v[80:95], a[120:123], a[216:219], v[80:95]
    v_mfma_f32_32x32x16_bf16 v[96:111], a[248:251], a[88:91], v[96:111]
    buffer_load_dwordx4 v13, s[44:47], s81 offen offset:1024 lds
    v_mfma_f32_32x32x16_bf16 v[112:127], a[248:251], a[216:219], v[112:127]
    s_waitcnt vmcnt(8)
    s_add_u32 s68, s100, 10502144
    v_mov_b32 v62, 0
    v_mov_b32 v63, s64
    s_mov_b64 exec, 1
    buffer_store_dword v63, v62, s[48:51], s68 offen sc1
    s_mov_b64 exec, -1
    s_add_u32 s27, s101, 8192
    buffer_load_dword v36, v35, s[48:51], s27 offen sc1
    s_add_u32 m0, s77, 10240
    s_add_u32 s81, s81, 16384
    s_and_b32 s81, s81, 131071
    buffer_load_dwordx4 v12, s[44:47], s81 offen lds
    buffer_load_dwordx4 v13, s[44:47], s81 offen offset:1024 lds
    s_add_u32 m0, s77, 12288
    s_add_u32 s81, s81, 16384
    s_and_b32 s81, s81, 131071
    buffer_load_dwordx4 v12, s[44:47], s81 offen lds
    buffer_load_dwordx4 v13, s[44:47], s81 offen offset:1024 lds
    s_add_u32 m0, s77, 14336
    s_add_u32 s81, s81, 16384
    s_and_b32 s81, s81, 131071
    buffer_load_dwordx4 v12, s[44:47], s81 offen lds
    buffer_load_dwordx4 v13, s[44:47], s81 offen offset:1024 lds
    s_waitcnt lgkmcnt(15)
    s_waitcnt vmcnt(39)
    v_mfma_f32_32x32x16_bf16 v[64:79], a[124:127], a[92:95], v[64:79]
    v_mfma_f32_32x32x16_bf16 v[80:95], a[124:127], a[220:223], v[80:95]
    v_mfma_f32_32x32x16_bf16 v[96:111], a[252:255], a[92:95], v[96:111]
    v_mfma_f32_32x32x16_bf16 v[112:127], a[252:255], a[220:223], v[112:127]
    s_waitcnt lgkmcnt(15)
    s_waitcnt vmcnt(32)
    s_waitcnt vmcnt(63)
    v_mfma_f32_32x32x16_bf16 v[64:79], v[14:17], a[96:99], v[64:79]
    ds_read_b64_tr_b16 v[48:49], v27 offset:0
    v_mfma_f32_32x32x16_bf16 v[80:95], v[14:17], a[224:227], v[80:95]
    ds_read_b64_tr_b16 v[50:51], v27 offset:1024
    s_waitcnt vmcnt(6)
    v_cmp_ne_u32 vcc, s64, v36
    s_nop 1
    s_cbranch_vccnz LQ_pdone38_ool4
LQ_pdone38:
    s_lshl_b32 s71, s56, 4
    s_sub_u32 s71, s78, s71
    s_lshl_b32 s71, s71, 10
    v_add_u32 v31, s71, v31
    v_add_u32 v32, s71, v32
    s_lshr_b32 s82, s65, 2
    s_lshl_b32 s82, s82, 10
    buffer_load_dwordx4 a[32:35], v31, s[48:51], s82 offen sc1
    buffer_load_dwordx4 a[160:163], v32, s[48:51], s82 offen sc1
    s_add_u32 s82, s82, 1024
    s_cmp_eq_u32 s82, s80
    s_cselect_b32 s82, 0, s82
    buffer_load_dwordx4 a[36:39], v31, s[48:51], s82 offen sc1
    buffer_load_dwordx4 a[164:167], v32, s[48:51], s82 offen sc1
    s_add_u32 s82, s82, 1024
    s_cmp_eq_u32 s82, s80
    s_cselect_b32 s82, 0, s82
    s_lshl_b32 s68, s62, 8
    s_lshl_b32 s69, s61, 7
    s_add_u32 s68, s68, 9437184
    s_add_u32 s69, s69, s68
    s_xor_b32 s70, s69, 128
    v_and_b32 v56, 31, v1
    v_lshlrev_b32 v56, 2, v56
    buffer_load_dword v38, v56, s[48:51], s69 offen sc1
    buffer_load_dword v39, v56, s[48:51], s70 offen sc1
    v_mfma_f32_32x32x16_bf16 v[96:111], v[18:21], a[96:99], v[96:111]
    ds_read_b64_tr_b16 v[52:53], v28 offset:0
    v_mfma_f32_32x32x16_bf16 v[112:127], v[18:21], a[224:227], v[112:127]
    ds_read_b64_tr_b16 v[54:55], v28 offset:1024
    s_waitcnt lgkmcnt(0)
    s_waitcnt vmcnt(36)
    s_waitcnt vmcnt(63)
    v_mfma_f32_32x32x16_bf16 v[64:79], v[48:51], a[100:103], v[64:79]
    ds_read_b64_tr_b16 v[40:41], v27 offset:2048
    buffer_load_dwordx4 a[40:43], v31, s[48:51], s82 offen sc1
    buffer_load_dwordx4 a[168:171], v32, s[48:51], s82 offen sc1
    v_mfma_f32_32x32x16_bf16 v[80:95], v[48:51], a[228:231], v[80:95]
    ds_read_b64_tr_b16 v[42:43], v27 offset:3072
    s_add_u32 s82, s82, 1024
    s_cmp_eq_u32 s82, s80
    s_cselect_b32 s82, 0, s82
    buffer_load_dwordx4 a[44:47], v31, s[48:51], s82 offen sc1
    v_mfma_f32_32x32x16_bf16 v[96:111], v[52:55], a[100:103], v[96:111]
    ds_read_b64_tr_b16 v[44:45], v28 offset:2048
    buffer_load_dwordx4 a[172:175], v32, s[48:51], s82 offen sc1
    v_mfma_f32_32x32x16_bf16 v[112:127], v[52:55], a[228:231], v[112:127]
    ds_read_b64_tr_b16 v[46:47], v28 offset:3072
    s_add_u32 s82, s82, 1024
    s_cmp_eq_u32 s82, s80
    s_cselect_b32 s82, 0, s82
    s_waitcnt lgkmcnt(0)
    s_waitcnt vmcnt(38)
    s_waitcnt vmcnt(63)
    v_mfma_f32_32x32x16_bf16 v[64:79], v[40:43], a[104:107], v[64:79]
    ds_read_b64_tr_b16 v[48:49], v27 offset:4096
    v_mfma_f32_32x32x16_bf16 v[80:95], v[40:43], a[232:235], v[80:95]
    ds_read_b64_tr_b16 v[50:51], v27 offset:5120
    buffer_load_dwordx4 a[48:51], v31, s[48:51], s82 offen sc1
    buffer_load_dwordx4 a[176:179], v32, s[48:51], s82 offen sc1
    s_add_u32 s82, s82, 1024
    s_cmp_eq_u32 s82, s80
    s_cselect_b32 s82, 0, s82
    s_cmp_ge_u32 s56, 2
    s_cbranch_scc1 LQ_skip40
    buffer_load_dwordx4 a[52:55], v31, s[48:51], s82 offen sc1
    buffer_load_dwordx4 a[180:183], v32, s[48:51], s82 offen sc1
LQ_skip40:
    v_mfma_f32_32x32x16_bf16 v[96:111], v[44:47], a[104:107], v[96:111]
    ds_read_b64_tr_b16 v[52:53], v28 offset:4096
    v_mfma_f32_32x32x16_bf16 v[112:127], v[44:47], a[232:235], v[112:127]
    ds_read_b64_tr_b16 v[54:55], v28 offset:5120
    s_lshl_b32 s68, s61, 1
    s_sub_u32 s68, 1, s68
    s_lshl_b32 s68, s68, 14
    v_add_u32 v2, s68, v29
    v_add_u32 v3, s68, v30
    s_waitcnt vmcnt(12)
    s_barrier
    s_waitcnt lgkmcnt(0)
    s_waitcnt vmcnt(36)
    s_waitcnt vmcnt(63)
    v_mfma_f32_32x32x16_bf16 v[64:79], v[48:51], a[108:111], v[64:79]
    ds_read_b64_tr_b16 v[40:41], v27 offset:6144
    ds_read_b64_tr_b16 v[42:43], v27 offset:7168
    ds_read_b64_tr_b16 v[44:45], v28 offset:6144
    v_mfma_f32_32x32x16_bf16 v[80:95], v[48:51], a[236:239], v[80:95]
    ds_read_b64_tr_b16 v[46:47], v28 offset:7168
    ds_read_b64_tr_b16 v[128:129], v29 offset:0
    ds_read_b64_tr_b16 v[130:131], v29 offset:1024
    s_add_u32 s27, s101, 16384
    buffer_load_dword v36, v35, s[48:51], s27 offen sc1
    v_mfma_f32_32x32x16_bf16 v[96:111], v[52:55], a[108:111], v[96:111]
    ds_read_b64_tr_b16 v[132:133], v30 offset:0
    ds_read_b64_tr_b16 v[134:135], v30 offset:1024
    ds_read_b64_tr_b16 v[136:137], v29 offset:2048
    v_mfma_f32_32x32x16_bf16 v[112:127], v[52:55], a[236:239], v[112:127]
    ds_read_b64_tr_b16 v[138:139], v29 offset:3072
    ds_read_b64_tr_b16 v[140:141], v30 offset:2048
    ds_read_b64_tr_b16 v[142:143], v30 offset:3072
    s_waitcnt lgkmcnt(8)
    s_waitcnt vmcnt(35)
    s_waitcnt vmcnt(63)
    v_mfma_f32_32x32x16_bf16 v[64:79], v[40:43], a[112:115], v[64:79]
    ds_read_b64_tr_b16 v[48:49], v27 offset:8192
    ds_read_b64_tr_b16 v[50:51], v27 offset:9216
    ds_read_b64_tr_b16 v[52:53], v28 offset:8192
    v_mfma_f32_32x32x16_bf16 v[80:95], v[40:43], a[240:243], v[80:95]
    ds_read_b64_tr_b16 v[54:55], v28 offset:9216
    ds_read_b64_tr_b16 v[144:145], v29 offset:4096
    ds_read_b64_tr_b16 v[146:147], v29 offset:5120
    v_mfma_f32_32x32x16_bf16 v[96:111], v[44:47], a[112:115], v[96:111]
    ds_read_b64_tr_b16 v[148:149], v30 offset:4096
    ds_read_b64_tr_b16 v[150:151], v30 offset:5120
    ds_read_b64_tr_b16 v[152:153], v29 offset:6144
    v_mfma_f32_32x32x16_bf16 v[112:127], v[44:47], a[240:243], v[112:127]
    ds_read_b64_tr_b16 v[154:155], v29 offset:7168
    ds_read_b64_tr_b16 v[156:157], v30 offset:6144
    ds_read_b64_tr_b16 v[158:159], v30 offset:7168
    s_waitcnt lgkmcnt(8)
    s_waitcnt vmcnt(27)
    v_mfma_f32_32x32x16_bf16 v[64:79], v[48:51], a[116:119], v[64:79]
    ds_read_b64_tr_b16 v[192:193], v29 offset:8192
    ds_read_b64_tr_b16 v[194:195], v29 offset:9216
    v_mfma_f32_32x32x16_bf16 v[80:95], v[48:51], a[244:247], v[80:95]
    ds_read_b64_tr_b16 v[196:197], v30 offset:8192
    ds_read_b64_tr_b16 v[198:199], v30 offset:9216
    v_mfma_f32_32x32x16_bf16 v[96:111], v[52:55], a[116:119], v[96:111]
    ds_read_b64_tr_b16 v[200:201], v29 offset:10240
    ds_read_b64_tr_b16 v[202:203], v29 offset:11264
    v_mfma_f32_32x32x16_bf16 v[112:127], v[52:55], a[244:247], v[112:127]
    ds_read_b64_tr_b16 v[204:205], v30 offset:10240
    ds_read_b64_tr_b16 v[206:207], v30 offset:11264
    s_waitcnt vmcnt(63)
    ds_read_b64_tr_b16 v[40:41], v27 offset:10240
    ds_read_b64_tr_b16 v[42:43], v27 offset:11264
    ds_read_b64_tr_b16 v[44:45], v28 offset:10240
    ds_read_b64_tr_b16 v[46:47], v28 offset:11264
    s_lshl_b32 s71, s56, 3
    s_add_u32 s71, s71, 86
    s_sub_u32 s71, s71, s78
    s_lshl_b32 s71, s71, 10
    v_add_u32 v31, s71, v31
    s_lshl_b32 s68, s61, 1
    s_sub_u32 s68, 1, s68
    s_lshl_b32 s69, s68, 13
    v_add_u32 v32, s69, v31
    s_lshr_b32 s82, s65, 1
    s_lshl_b32 s82, s82, 10
    s_waitcnt vmcnt(0)
    v_cmp_ne_u32 vcc, s64, v36
    s_mov_b32 s85, 0
    s_nop 0
    s_cbranch_vccnz LQ_oearly41
    buffer_load_dwordx4 a[0:3], v31, s[48:51], s82 offen sc1
    buffer_load_dwordx4 a[128:131], v32, s[48:51], s82 offen sc1
    s_add_u32 s82, s82, 1024
    s_and_b32 s82, s82, 8191
    buffer_load_dwordx4 a[4:7], v31, s[48:51], s82 offen sc1
    buffer_load_dwordx4 a[132:135], v32, s[48:51], s82 offen sc1
    s_add_u32 s82, s82, 1024
    s_and_b32 s82, s82, 8191
    buffer_load_dwordx4 a[8:11], v31, s[48:51], s82 offen sc1
    buffer_load_dwordx4 a[136:139], v32, s[48:51], s82 offen sc1
    s_add_u32 s82, s82, 1024
    s_and_b32 s82, s82, 8191
    buffer_load_dwordx4 a[12:15], v31, s[48:51], s82 offen sc1
    buffer_load_dwordx4 a[140:143], v32, s[48:51], s82 offen sc1
    s_add_u32 s82, s82, 1024
    s_and_b32 s82, s82, 8191
    buffer_load_dwordx4 a[16:19], v31, s[48:51], s82 offen sc1
    buffer_load_dwordx4 a[144:147], v32, s[48:51], s82 offen sc1
    s_add_u32 s82, s82, 1024
    s_and_b32 s82, s82, 8191
    buffer_load_dwordx4 a[20:23], v31, s[48:51], s82 offen sc1
    buffer_load_dwordx4 a[148:151], v32, s[48:51], s82 offen sc1
    s_add_u32 s82, s82, 1024
    s_and_b32 s82, s82, 8191
    buffer_load_dwordx4 a[24:27], v31, s[48:51], s82 offen sc1
    buffer_load_dwordx4 a[152:155], v32, s[48:51], s82 offen sc1
    s_add_u32 s82, s82, 1024
    s_and_b32 s82, s82, 8191
    buffer_load_dwordx4 a[28:31], v31, s[48:51], s82 offen sc1
    buffer_load_dwordx4 a[156:159], v32, s[48:51], s82 offen sc1
    s_mov_b32 s85, 1
LQ_oearly41:
    v_sub_f32 v56, 1.0, v38
    v_sub_f32 v57, 1.0, v39
    s_xor_b32 s68, s56, 1
    s_mul_i32 s68, s68, 22528
    s_add_u32 s68, s68, 4096
    v_lshl_add_u32 v61, v1, 4, s68
    s_xor_b32 s68, s56, 2
    s_mul_i32 s68, s68, 22528
    s_add_u32 s68, s68, 8192
    v_lshl_add_u32 v62, v1, 4, s68
    s_xor_b32 s68, s56, 3
    s_mul_i32 s68, s68, 22528
    s_add_u32 s68, s68, 12288
    v_lshl_add_u32 v63, v1, 4, s68
    s_add_u32 s68, s76, 4096
    v_lshl_add_u32 v60, v1, 4, s68
    s_lshl_b32 s68, s62, 6
    s_lshl_b32 s69, s61, 5
    s_add_u32 s68, s68, s69
    s_lshl_b32 s68, s68, 10
    s_lshl_b32 s69, s63, 7
    s_add_u32 s68, s68, s69
    s_lshl_b32 s69, s60, 6
    s_add_u32 s83, s68, s69
    v_and_b32 v58, 31, v1
    v_lshrrev_b32 v59, 5, v1
    s_mul_i32 s69, s61, 4608
    s_add_u32 s69, s69, 98304
    s_lshl_b32 s71, s60, 6
    s_add_u32 s71, s71, s69
    v_mul_u32_u24 v58, 144, v58
    v_lshl_add_u32 v58, v59, 3, v58
    v_add_u32 v4, s71, v58
    v_lshrrev_b32 v58, 3, v1
    s_lshl_b32 s71, s60, 4
    v_add_u32 v58, s71, v58
    v_and_b32 v59, 7, v1
    v_lshlrev_b32 v59, 4, v59
    v_mul_u32_u24 v5, 144, v58
    v_add3_u32 v5, v5, v59, s69
    v_lshl_add_u32 v58, v58, 10, v59
    v_add_u32 v59, 8192, v58
    s_mov_b32 s83, s68
    s_waitcnt lgkmcnt(0)
    v_mfma_f32_32x32x16_bf16 v[64:79], v[40:43], a[32:35], v[64:79]
    ds_read_b64_tr_b16 v[48:49], v27 offset:12288
    ds_read_b64_tr_b16 v[50:51], v27 offset:13312
    ds_read_b64_tr_b16 v[52:53], v28 offset:12288
    v_mfma_f32_32x32x16_bf16 v[80:95], v[40:43], a[160:163], v[80:95]
    ds_read_b64_tr_b16 v[54:55], v28 offset:13312
    ds_read_b64_tr_b16 v[208:209], v29 offset:12288
    ds_read_b64_tr_b16 v[210:211], v29 offset:13312
    v_mfma_f32_32x32x16_bf16 v[96:111], v[44:47], a[32:35], v[96:111]
    ds_read_b64_tr_b16 v[212:213], v30 offset:12288
    ds_read_b64_tr_b16 v[214:215], v30 offset:13312
    ds_read_b64_tr_b16 v[216:217], v29 offset:14336
    v_mfma_f32_32x32x16_bf16 v[112:127], v[44:47], a[160:163], v[112:127]
    ds_read_b64_tr_b16 v[218:219], v29 offset:15360
    ds_read_b64_tr_b16 v[220:221], v30 offset:14336
    ds_read_b64_tr_b16 v[222:223], v30 offset:15360
    s_waitcnt lgkmcnt(8)
    v_mfma_f32_32x32x16_bf16 v[64:79], v[48:51], a[36:39], v[64:79]
    ds_read_b64_tr_b16 v[40:41], v27 offset:14336
    ds_read_b64_tr_b16 v[42:43], v27 offset:15360
    ds_read_b64_tr_b16 v[44:45], v28 offset:14336
    v_mfma_f32_32x32x16_bf16 v[80:95], v[48:51], a[164:167], v[80:95]
    ds_read_b64_tr_b16 v[46:47], v28 offset:15360
    ds_read_b64_tr_b16 v[224:225], v2 offset:0
    ds_read_b64_tr_b16 v[226:227], v2 offset:1024
    v_mfma_f32_32x32x16_bf16 v[96:111], v[52:55], a[36:39], v[96:111]
    ds_read_b64_tr_b16 v[228:229], v3 offset:0
    ds_read_b64_tr_b16 v[230:231], v3 offset:1024
    ds_read_b64_tr_b16 v[232:233], v2 offset:2048
    v_mfma_f32_32x32x16_bf16 v[112:127], v[52:55], a[164:167], v[112:127]
    ds_read_b64_tr_b16 v[234:235], v2 offset:3072
    ds_read_b64_tr_b16 v[236:237], v3 offset:2048
    ds_read_b64_tr_b16 v[238:239], v3 offset:3072
    s_waitcnt lgkmcnt(8)
    v_mfma_f32_32x32x16_bf16 v[64:79], v[40:43], a[40:43], v[64:79]
    ds_read_b64_tr_b16 v[48:49], v27 offset:16384
    ds_read_b64_tr_b16 v[50:51], v27 offset:17408
    ds_read_b64_tr_b16 v[52:53], v28 offset:16384
    v_mfma_f32_32x32x16_bf16 v[80:95], v[40:43], a[168:171], v[80:95]
    ds_read_b64_tr_b16 v[54:55], v28 offset:17408
    ds_read_b64_tr_b16 v[240:241], v2 offset:4096
    ds_read_b64_tr_b16 v[242:243], v2 offset:5120
    v_mfma_f32_32x32x16_bf16 v[96:111], v[44:47], a[40:43], v[96:111]
    ds_read_b64_tr_b16 v[244:245], v3 offset:4096
    ds_read_b64_tr_b16 v[246:247], v3 offset:5120
    ds_read_b64_tr_b16 v[248:249], v2 offset:6144
    v_mfma_f32_32x32x16_bf16 v[112:127], v[44:47], a[168:171], v[112:127]
    ds_read_b64_tr_b16 v[250:251], v2 offset:7168
    ds_read_b64_tr_b16 v[252:253], v3 offset:6144
    ds_read_b64_tr_b16 v[254:255], v3 offset:7168
    s_waitcnt lgkmcnt(8)
    v_mfma_f32_32x32x16_bf16 v[64:79], v[48:51], a[44:47], v[64:79]
    ds_read_b64_tr_b16 v[40:41], v27 offset:18432
    ds_read_b64_tr_b16 v[42:43], v27 offset:19456
    ds_read_b64_tr_b16 v[44:45], v28 offset:18432
    v_mfma_f32_32x32x16_bf16 v[80:95], v[48:51], a[172:175], v[80:95]
    ds_read_b64_tr_b16 v[46:47], v28 offset:19456
    ds_read_b64_tr_b16 a[56:57], v2 offset:8192
    ds_read_b64_tr_b16 a[58:59], v2 offset:9216
    v_mfma_f32_32x32x16_bf16 v[96:111], v[52:55], a[44:47], v[96:111]
    ds_read_b64_tr_b16 a[184:185], v3 offset:8192
    ds_read_b64_tr_b16 a[186:187], v3 offset:9216
    ds_read_b64_tr_b16 a[60:61], v2 offset:10240
    v_mfma_f32_32x32x16_bf16 v[112:127], v[52:55], a[172:175], v[112:127]
    ds_read_b64_tr_b16 a[62:63], v2 offset:11264
    ds_read_b64_tr_b16 a[188:189], v3 offset:10240
    ds_read_b64_tr_b16 a[190:191], v3 offset:11264
    s_waitcnt lgkmcnt(8)
    v_mfma_f32_32x32x16_bf16 v[64:79], v[40:43], a[48:51], v[64:79]
    ds_read_b64_tr_b16 v[48:49], v27 offset:20480
    ds_read_b64_tr_b16 v[50:51], v27 offset:21504
    ds_read_b64_tr_b16 v[52:53], v28 offset:20480
    v_mfma_f32_32x32x16_bf16 v[80:95], v[40:43], a[176:179], v[80:95]
    ds_read_b64_tr_b16 v[54:55], v28 offset:21504
    ds_read_b64_tr_b16 a[64:65], v2 offset:12288
    ds_read_b64_tr_b16 a[66:67], v2 offset:13312
    v_mfma_f32_32x32x16_bf16 v[96:111], v[44:47], a[48:51], v[96:111]
    ds_read_b64_tr_b16 a[192:193], v3 offset:12288
    ds_read_b64_tr_b16 a[194:195], v3 offset:13312
    ds_read_b64_tr_b16 a[68:69], v2 offset:14336
    v_mfma_f32_32x32x16_bf16 v[112:127], v[44:47], a[176:179], v[112:127]
    ds_read_b64_tr_b16 a[70:71], v2 offset:15360
    ds_read_b64_tr_b16 a[196:197], v3 offset:14336
    ds_read_b64_tr_b16 a[198:199], v3 offset:15360
    s_cmp_ge_u32 s56, 2
    s_cbranch_scc1 LQ_s2145
    s_waitcnt lgkmcnt(8)
    v_mfma_f32_32x32x16_bf16 v[64:79], v[48:51], a[52:55], v[64:79]
    v_mfma_f32_32x32x16_bf16 v[80:95], v[48:51], a[180:183], v[80:95]
    v_mfma_f32_32x32x16_bf16 v[96:111], v[52:55], a[52:55], v[96:111]
    v_mfma_f32_32x32x16_bf16 v[112:127], v[52:55], a[180:183], v[112:127]
LQ_s2145:
    s_cmp_lg_u32 s85, 0
    s_cbranch_scc0 LQ_olate46_ool5
LQ_olate46:
    s_waitcnt lgkmcnt(0)
    s_barrier
    s_waitcnt vmcnt(14)
    v_mfma_f32_32x32x16_bf16 v[176:191], v[132:135], a[0:3], 0
    s_nop 3
    v_mul_f32 v80, v57, v80
    v_mul_f32 v81, v57, v81
    v_mul_f32 v82, v57, v82
    v_mul_f32 v83, v57, v83
    v_mul_f32 v84, v57, v84
    v_mfma_f32_32x32x16_bf16 v[160:175], v[128:131], a[0:3], 0
    v_mul_f32 v85, v57, v85
    v_mul_f32 v86, v57, v86
    v_mul_f32 v87, v57, v87
    v_mul_f32 v88, v57, v88
    v_mul_f32 v89, v57, v89
    v_mfma_f32_32x32x16_bf16 v[176:191], v[228:231], a[128:131], v[176:191]
    v_mul_f32 v90, v57, v90
    v_mul_f32 v91, v57, v91
    v_mul_f32 v92, v57, v92
    v_mul_f32 v93, v57, v93
    v_mul_f32 v94, v57, v94
    v_mfma_f32_32x32x16_bf16 v[160:175], v[224:227], a[128:131], v[160:175]
    v_mul_f32 v95, v57, v95
    ds_write_b128 v61, v[80:83] offset:0
    ds_write_b128 v61, v[84:87] offset:1024
    ds_write_b128 v61, v[88:91] offset:2048
    ds_write_b128 v61, v[92:95] offset:3072
    s_waitcnt vmcnt(12)
    v_mfma_f32_32x32x16_bf16 v[176:191], v[140:143], a[4:7], v[176:191]
    v_mul_f32 v112, v57, v112
    v_mul_f32 v113, v57, v113
    v_mul_f32 v114, v57, v114
    v_mul_f32 v115, v57, v115
    v_mul_f32 v116, v57, v116
    v_mfma_f32_32x32x16_bf16 v[160:175], v[136:139], a[4:7], v[160:175]
    v_mul_f32 v117, v57, v117
    v_mul_f32 v118, v57, v118
    v_mul_f32 v119, v57, v119
    v_mul_f32 v120, v57, v120
    v_mul_f32 v121, v57, v121
    v_mfma_f32_32x32x16_bf16 v[176:191], v[236:239], a[132:135], v[176:191]
    v_mul_f32 v122, v57, v122
    v_mul_f32 v123, v57, v123
    v_mul_f32 v124, v57, v124
    v_mul_f32 v125, v57, v125
    v_mul_f32 v126, v57, v126
    v_mfma_f32_32x32x16_bf16 v[160:175], v[232:235], a[132:135], v[160:175]
    v_mul_f32 v127, v57, v127
    ds_write_b128 v63, v[112:115] offset:0
    ds_write_b128 v63, v[116:119] offset:1024
    ds_write_b128 v63, v[120:123] offset:2048
    ds_write_b128 v63, v[124:127] offset:3072
    s_waitcnt vmcnt(10)
    v_mfma_f32_32x32x16_bf16 v[176:191], v[148:151], a[8:11], v[176:191]
    v_mul_f32 v96, v56, v96
    v_mul_f32 v97, v56, v97
    v_mul_f32 v98, v56, v98
    v_mul_f32 v99, v56, v99
    v_mul_f32 v100, v56, v100
    v_mfma_f32_32x32x16_bf16 v[176:191], v[244:247], a[136:139], v[176:191]
    v_mul_f32 v101, v56, v101
    v_mul_f32 v102, v56, v102
    v_mul_f32 v103, v56, v103
    v_mul_f32 v104, v56, v104
    v_mul_f32 v105, v56, v105
    s_waitcnt vmcnt(8)
    v_mfma_f32_32x32x16_bf16 v[176:191], v[156:159], a[12:15], v[176:191]
    v_mul_f32 v106, v56, v106
    v_mul_f32 v107, v56, v107
    v_mul_f32 v108, v56, v108
    v_mul_f32 v109, v56, v109
    v_mul_f32 v110, v56, v110
    v_mfma_f32_32x32x16_bf16 v[176:191], v[252:255], a[140:143], v[176:191]
    v_mul_f32 v111, v56, v111
    s_waitcnt lgkmcnt(0)
    s_barrier
    ds_read_b128 v[80:83], v60 offset:0
    ds_read_b128 v[84:87], v60 offset:1024
    s_waitcnt vmcnt(6)
    v_mfma_f32_32x32x16_bf16 v[176:191], v[196:199], a[16:19], v[176:191]
    ds_read_b128 v[88:91], v60 offset:2048
    ds_read_b128 v[92:95], v60 offset:3072
    ds_read_b128 v[112:115], v60 offset:8192
    ds_read_b128 v[116:119], v60 offset:9216
    ds_read_b128 v[120:123], v60 offset:10240
    v_mfma_f32_32x32x16_bf16 v[176:191], a[184:187], a[144:147], v[176:191]
    ds_read_b128 v[124:127], v60 offset:11264
    v_mul_f32 v64, v56, v64
    v_mul_f32 v65, v56, v65
    v_mul_f32 v66, v56, v66
    v_mul_f32 v67, v56, v67
    s_waitcnt vmcnt(4)
    v_mfma_f32_32x32x16_bf16 v[176:191], v[204:207], a[20:23], v[176:191]
    v_mul_f32 v68, v56, v68
    v_mul_f32 v69, v56, v69
    v_mul_f32 v70, v56, v70
    v_mul_f32 v71, v56, v71
    v_mul_f32 v72, v56, v72
    v_mfma_f32_32x32x16_bf16 v[176:191], a[188:191], a[148:151], v[176:191]
    v_mul_f32 v73, v56, v73
    v_mul_f32 v74, v56, v74
    v_mul_f32 v75, v56, v75
    v_mul_f32 v76, v56, v76
    v_mul_f32 v77, v56, v77
    s_waitcnt vmcnt(2)
    v_mfma_f32_32x32x16_bf16 v[176:191], v[212:215], a[24:27], v[176:191]
    v_mul_f32 v78, v56, v78
    v_mul_f32 v79, v56, v79
    v_mfma_f32_32x32x16_bf16 v[176:191], a[192:195], a[152:155], v[176:191]
    s_waitcnt vmcnt(0)
    v_mfma_f32_32x32x16_bf16 v[176:191], v[220:223], a[28:31], v[176:191]
    v_mfma_f32_32x32x16_bf16 v[176:191], a[196:199], a[156:159], v[176:191]
    v_mfma_f32_32x32x16_bf16 v[160:175], v[144:147], a[8:11], v[160:175]
    s_waitcnt lgkmcnt(4)
    v_add_f32 v64, v64, v80
    v_add_f32 v65, v65, v81
    v_add_f32 v66, v66, v82
    v_add_f32 v67, v67, v83
    v_add_f32 v68, v68, v84
    v_mfma_f32_32x32x16_bf16 v[160:175], v[240:243], a[136:139], v[160:175]
    v_add_f32 v69, v69, v85
    v_add_f32 v70, v70, v86
    v_add_f32 v71, v71, v87
    v_add_f32 v72, v72, v88
    v_add_f32 v73, v73, v89
    v_add_f32 v74, v74, v90
    v_mfma_f32_32x32x16_bf16 v[160:175], v[152:155], a[12:15], v[160:175]
    v_add_f32 v75, v75, v91
    v_add_f32 v76, v76, v92
    v_add_f32 v77, v77, v93
    v_add_f32 v78, v78, v94
    v_add_f32 v79, v79, v95
    s_waitcnt lgkmcnt(0)
    v_mfma_f32_32x32x16_bf16 v[160:175], v[248:251], a[140:143], v[160:175]
    v_fmac_f32 v96, v38, v176
    v_fmac_f32 v97, v38, v177
    v_fmac_f32 v98, v38, v178
    v_fmac_f32 v99, v38, v179
    ds_write_b128 v62, v[96:99] offset:0
    v_mfma_f32_32x32x16_bf16 v[160:175], v[192:195], a[16:19], v[160:175]
    v_fmac_f32 v100, v38, v180
    v_fmac_f32 v101, v38, v181
    v_fmac_f32 v102, v38, v182
    v_fmac_f32 v103, v38, v183
    ds_write_b128 v62, v[100:103] offset:1024
    v_mfma_f32_32x32x16_bf16 v[160:175], a[56:59], a[144:147], v[160:175]
    v_fmac_f32 v104, v38, v184
    v_fmac_f32 v105, v38, v185
    v_fmac_f32 v106, v38, v186
    v_fmac_f32 v107, v38, v187
    ds_write_b128 v62, v[104:107] offset:2048
    v_mfma_f32_32x32x16_bf16 v[160:175], v[200:203], a[20:23], v[160:175]
    v_fmac_f32 v108, v38, v188
    v_fmac_f32 v109, v38, v189
    v_fmac_f32 v110, v38, v190
    v_fmac_f32 v111, v38, v191
    ds_write_b128 v62, v[108:111] offset:3072
    v_mfma_f32_32x32x16_bf16 v[160:175], a[60:63], a[148:151], v[160:175]
    v_add_f32 v64, v64, v112
    v_add_f32 v65, v65, v113
    v_add_f32 v66, v66, v114
    v_add_f32 v67, v67, v115
    v_add_f32 v68, v68, v116
    v_add_f32 v69, v69, v117
    s_waitcnt lgkmcnt(0)
    s_barrier
    v_mfma_f32_32x32x16_bf16 v[160:175], v[208:211], a[24:27], v[160:175]
    ds_read_b128 v[96:99], v60 offset:4096
    ds_read_b128 v[100:103], v60 offset:5120
    ds_read_b128 v[104:107], v60 offset:6144
    ds_read_b128 v[108:111], v60 offset:7168
    v_mfma_f32_32x32x16_bf16 v[160:175], a[64:67], a[152:155], v[160:175]
    v_add_f32 v70, v70, v118
    v_add_f32 v71, v71, v119
    v_add_f32 v72, v72, v120
    v_add_f32 v73, v73, v121
    v_add_f32 v74, v74, v122
    v_add_f32 v75, v75, v123
    v_mfma_f32_32x32x16_bf16 v[160:175], v[216:219], a[28:31], v[160:175]
    v_add_f32 v76, v76, v124
    v_add_f32 v77, v77, v125
    v_add_f32 v78, v78, v126
    v_add_f32 v79, v79, v127
    v_mfma_f32_32x32x16_bf16 v[160:175], a[68:71], a[156:159], v[160:175]
    s_waitcnt lgkmcnt(0)
    v_pk_add_f32 v[64:65], v[64:65], v[96:97]
    v_pk_add_f32 v[66:67], v[66:67], v[98:99]
    v_pk_add_f32 v[68:69], v[68:69], v[100:101]
    v_pk_add_f32 v[70:71], v[70:71], v[102:103]
    v_pk_add_f32 v[72:73], v[72:73], v[104:105]
    v_pk_add_f32 v[74:75], v[74:75], v[106:107]
    v_pk_add_f32 v[76:77], v[76:77], v[108:109]
    v_pk_add_f32 v[78:79], v[78:79], v[110:111]
    s_nop 2
    v_pk_fma_f32 v[64:65], v[160:161], v[38:39], v[64:65] op_sel_hi:[1,0,1]
    v_pk_fma_f32 v[66:67], v[162:163], v[38:39], v[66:67] op_sel_hi:[1,0,1]
    v_pk_fma_f32 v[68:69], v[164:165], v[38:39], v[68:69] op_sel_hi:[1,0,1]
    v_pk_fma_f32 v[70:71], v[166:167], v[38:39], v[70:71] op_sel_hi:[1,0,1]
    v_pk_fma_f32 v[72:73], v[168:169], v[38:39], v[72:73] op_sel_hi:[1,0,1]
    v_pk_fma_f32 v[74:75], v[170:171], v[38:39], v[74:75] op_sel_hi:[1,0,1]
    v_pk_fma_f32 v[76:77], v[172:173], v[38:39], v[76:77] op_sel_hi:[1,0,1]
    v_pk_fma_f32 v[78:79], v[174:175], v[38:39], v[78:79] op_sel_hi:[1,0,1]
    v_cvt_pk_bf16_f32 v80, v64, v65
    v_cvt_pk_bf16_f32 v81, v66, v67
    v_cvt_pk_bf16_f32 v82, v68, v69
    v_cvt_pk_bf16_f32 v83, v70, v71
    v_cvt_pk_bf16_f32 v84, v72, v73
    v_cvt_pk_bf16_f32 v85, v74, v75
    v_cvt_pk_bf16_f32 v86, v76, v77
    v_cvt_pk_bf16_f32 v87, v78, v79
    ds_write_b64 v4, v[80:81] offset:0
    ds_write_b64 v4, v[82:83] offset:16
    ds_write_b64 v4, v[84:85] offset:32
    ds_write_b64 v4, v[86:87] offset:48
    s_waitcnt lgkmcnt(0)
    s_barrier
    ds_read_b128 v[80:83], v5
    ds_read_b128 v[84:87], v5 offset:1152
    s_waitcnt lgkmcnt(1)
    buffer_store_dwordx4 v[80:83], v58, s[52:55], s83 offen sc0 sc1
    s_waitcnt lgkmcnt(0)
    buffer_store_dwordx4 v[84:87], v59, s[52:55], s83 offen sc0 sc1
    s_endpgm
LQ_nd31_ool1:
    s_mov_b32 s72, 400000
LQ_nl30:
    v_mov_b32 v36, 0
    global_load_dword v36, v36, s[22:23] sc1
    s_waitcnt vmcnt(0)
    s_sub_u32 s72, s72, 1
    s_cbranch_scc1 LQ_nx32
    v_readfirstlane_b32 s64, v36
    s_nop 3
    s_cmp_eq_u32 s64, 0
    s_cbranch_scc1 LQ_nl30
LQ_nx32:
    s_branch LQ_nd31
LQ_pdone35_ool2:
    s_mov_b32 s72, 400000
LQ_poll34:
    buffer_load_dword v36, v35, s[48:51], s101 offen offset:0 sc1
    s_waitcnt vmcnt(0)
    s_sub_u32 s72, s72, 1
    s_cbranch_scc1 LQ_px36
    v_cmp_ne_u32 vcc, s64, v36
    s_nop 1
    s_cbranch_vccnz LQ_poll34
LQ_px36:
    s_branch LQ_pdone35
LQ_pdone43_ool3:
    s_mov_b32 s72, 400000
LQ_poll42:
    buffer_load_dword v36, v35, s[48:51], s27 offen offset:0 sc1
    s_waitcnt vmcnt(0)
    s_sub_u32 s72, s72, 1
    s_cbranch_scc1 LQ_px44
    v_cmp_ne_u32 vcc, s64, v36
    s_nop 1
    s_cbranch_vccnz LQ_poll42
LQ_px44:
    s_branch LQ_pdone43
LQ_pdone38_ool4:
    s_mov_b32 s72, 400000
LQ_poll37:
    buffer_load_dword v36, v35, s[48:51], s27 offen offset:0 sc1
    s_waitcnt vmcnt(0)
    s_sub_u32 s72, s72, 1
    s_cbranch_scc1 LQ_px39
    v_cmp_ne_u32 vcc, s64, v36
    s_nop 1
    s_cbranch_vccnz LQ_poll37
LQ_px39:
    s_branch LQ_pdone38
LQ_olate46_ool5:
    s_waitcnt vmcnt(0)
    v_cmp_ne_u32 vcc, s64, v36
    s_nop 1
    s_cbranch_vccz LQ_pdone48
    s_mov_b32 s72, 400000
LQ_poll47:
    buffer_load_dword v36, v35, s[48:51], s27 offen offset:0 sc1
    s_waitcnt vmcnt(0)
    s_sub_u32 s72, s72, 1
    s_cbranch_scc1 LQ_px49
    v_cmp_ne_u32 vcc, s64, v36
    s_nop 1
    s_cbranch_vccnz LQ_poll47
LQ_px49:
LQ_pdone48:
    buffer_load_dwordx4 a[0:3], v31, s[48:51], s82 offen sc1
    buffer_load_dwordx4 a[128:131], v32, s[48:51], s82 offen sc1
    s_add_u32 s82, s82, 1024
    s_and_b32 s82, s82, 8191
    buffer_load_dwordx4 a[4:7], v31, s[48:51], s82 offen sc1
    buffer_load_dwordx4 a[132:135], v32, s[48:51], s82 offen sc1
    s_add_u32 s82, s82, 1024
    s_and_b32 s82, s82, 8191
    buffer_load_dwordx4 a[8:11], v31, s[48:51], s82 offen sc1
    buffer_load_dwordx4 a[136:139], v32, s[48:51], s82 offen sc1
    s_add_u32 s82, s82, 1024
    s_and_b32 s82, s82, 8191
    buffer_load_dwordx4 a[12:15], v31, s[48:51], s82 offen sc1
    buffer_load_dwordx4 a[140:143], v32, s[48:51], s82 offen sc1
    s_add_u32 s82, s82, 1024
    s_and_b32 s82, s82, 8191
    buffer_load_dwordx4 a[16:19], v31, s[48:51], s82 offen sc1
    buffer_load_dwordx4 a[144:147], v32, s[48:51], s82 offen sc1
    s_add_u32 s82, s82, 1024
    s_and_b32 s82, s82, 8191
    buffer_load_dwordx4 a[20:23], v31, s[48:51], s82 offen sc1
    buffer_load_dwordx4 a[148:151], v32, s[48:51], s82 offen sc1
    s_add_u32 s82, s82, 1024
    s_and_b32 s82, s82, 8191
    buffer_load_dwordx4 a[24:27], v31, s[48:51], s82 offen sc1
    buffer_load_dwordx4 a[152:155], v32, s[48:51], s82 offen sc1
    s_add_u32 s82, s82, 1024
    s_and_b32 s82, s82, 8191
    buffer_load_dwordx4 a[28:31], v31, s[48:51], s82 offen sc1
    buffer_load_dwordx4 a[156:159], v32, s[48:51], s82 offen sc1
    s_branch LQ_olate46
L_end:
    s_endpgm
.section .rodata,"a"
.p2align 6
.amdhsa_kernel gated_mix__linear_kernel_hedgehog__dense_activation_relu__prompt_kernel
  .amdhsa_next_free_vgpr 512
  .amdhsa_next_free_sgpr 102
  .amdhsa_accum_offset 256
  .amdhsa_group_segment_fixed_size 0
  .amdhsa_kernarg_size 88
  .amdhsa_user_sgpr_count 2
  .amdhsa_user_sgpr_kernarg_segment_ptr 1
  .amdhsa_system_sgpr_workgroup_id_x 1
.end_amdhsa_kernel
```
